```python
import torch

def _softmax(x, axis=-1):
    return torch.softmax(x, dim=axis)

def _gelu(x):
    return torch.nn.functional.gelu(x, approximate='tanh')

def _silu(x):
    return torch.nn.functional.silu(x)

def _sigmoid(x):
    return torch.sigmoid(x)

def _layernorm(x, axis=-1, eps=1e-05):
    m = x.mean(dim=axis, keepdim=True)
    v = x.var(dim=axis, keepdim=True, unbiased=False)
    return (x - m) / torch.sqrt(v + eps)

def _scatter_add(tgt, idx, src, axis=0):
    return tgt.clone().index_add_(axis, idx, src)

def _segment_sum(src, seg, n):
    out = torch.zeros((n,) + src.shape[1:], dtype=src.dtype)
    return out.index_add_(0, seg, src)

def _pad(x, pw):
    flat = tuple((v for pair in reversed(pw) for v in pair))
    return torch.nn.functional.pad(x, flat)
kernel_name = 'adaLN_cond__softmax_full_mha__dense_activation_relu__prompt'

def setup_inputs():

    _w = lambda a: (lambda t: t.to(torch.bfloat16) if t.is_floating_point() else t)(torch.as_tensor(a))

    def _A_setup():
        B, S, D = (1, 2048, 512)
        return {'x': _w((lambda *s: torch.randn(*s, dtype=torch.bfloat16) * 0.05)(B, S, D)), 'wqkv': _w((lambda *s: torch.randn(*s, dtype=torch.bfloat16) * 0.05)(D, 3 * D)), 'wo': _w((lambda *s: torch.randn(*s, dtype=torch.bfloat16) * 0.05)(D, D))}
    _A_in = _A_setup()

    def _B_setup():
        B, S, D, Dff = (1, 2048, 512, 1376)
        return {'x': _w((lambda *s: torch.randn(*s, dtype=torch.bfloat16) * 0.05)(B, S, D)), 'w1': _w((lambda *s: torch.randn(*s, dtype=torch.bfloat16) * 0.05)(D, Dff)), 'w2': _w((lambda *s: torch.randn(*s, dtype=torch.bfloat16) * 0.05)(Dff, D))}
    _B_in = _B_setup()
    return {'A_x': _A_in['x'], 'A_wqkv': _A_in['wqkv'], 'A_wo': _A_in['wo'], 'B_x': _B_in['x'], 'B_w1': _B_in['w1'], 'B_w2': _B_in['w2'], 'c': _w((lambda *s: torch.randn(*s, dtype=torch.bfloat16) * 0.1)(1, 512) * 8.0), 'w_mod': _w((lambda *s: torch.randn(*s, dtype=torch.bfloat16) * 0.1)(512, 6 * 512) * 512 ** (-0.5) * 8.0)}

def reference(A_x, A_wqkv, A_wo, B_x, B_w1, B_w2, c, w_mod):

    def _A_ref(x, wqkv, wo):
        B, S, D = x.shape
        H = 32
        Dh = D // H
        qkv = (lambda x, *d: x.permute(*d))((x @ wqkv).reshape(B, S, 3, H, Dh), 2, 0, 3, 1, 4)
        q, k, v = (qkv[0], qkv[1], qkv[2])
        scale = Dh ** (-0.5)
        scores = torch.einsum('bhqd,bhkd->bhqk', q, k) * scale
        p = _softmax(scores, axis=-1)
        o = torch.einsum('bhqk,bhkd->bhqd', p, v)
        return (lambda x, *d: x.permute(*d))(o, 0, 2, 1, 3).reshape(B, S, D) @ wo

    def _B_ref(x, w1, w2):
        h = torch.einsum('bsd,df->bsf', x, w1)
        zero = torch.zeros_like(h)
        h = torch.maximum(h, zero)
        return torch.einsum('bsf,fd->bsd', h, w2)
    x = A_x
    mod = (_silu(c) @ w_mod).reshape(c.shape[0], 6, 1, -1)
    sa, ca, ga, sb, cb, gb = (mod[:, 0].clone(), mod[:, 1].clone(), mod[:, 2].clone(), mod[:, 3].clone(), mod[:, 4].clone(), mod[:, 5].clone())
    h = _layernorm(x, axis=-1) * (1 + ca) + sa
    x = x + ga * _A_ref(h, A_wqkv, A_wo)
    h = _layernorm(x, axis=-1) * (1 + cb) + sb
    x = x + gb * _B_ref(h, B_w1, B_w2)
    return x
```

```asm
; @launch grid=(256,1,1) block=(512,1,1) lds=163840
.amdgcn_target "amdgcn-amd-amdhsa--gfx950"
.text
.globl adaLN_cond__softmax_full_mha__dense_activation_relu__prompt_kernel
.p2align 8
.type adaLN_cond__softmax_full_mha__dense_activation_relu__prompt_kernel,@function
adaLN_cond__softmax_full_mha__dense_activation_relu__prompt_kernel:
    s_cmp_ge_u32 s2, 256
    s_cbranch_scc1 L_end
    s_load_dwordx16 s[4:19], s[0:1], 0
    s_load_dwordx2 s[24:25], s[0:1], 80
    s_and_b32 s60, s2, 7
    s_lshr_b32 s61, s2, 3
    v_readfirstlane_b32 s3, v0
    v_lshrrev_b32 v1, 3, v0
    v_lshlrev_b32 v6, 4, v0
    v_mul_u32_u24 v3, 3072, v1
    v_and_b32 v2, 0x70, v6
    s_lshl_b32 s80, s60, 18
    s_lshl_b32 s77, s61, 13
    s_add_u32 s78, s80, s77
    v_add_u32 v5, s78, v6
    s_lshr_b32 s3, s3, 6
    s_getpc_b64 s[56:57]
L_pc:
    v_and_b32 v8, 15, v0
    s_and_b32 s57, s57, 0xffff
    s_mov_b32 s58, L_code_end-L_pc
    s_mov_b32 s59, 0x20000
    s_cmp_lg_u32 s3, 7
    s_cbranch_scc1 L_skip_1
    v_lshlrev_b32 v1, 7, v8
    s_lshl_b32 s77, s61, 11
    buffer_load_dword v37, v1, s[56:59], s77 offen
L_skip_1:
    s_cmp_ge_u32 s61, 24
    s_cbranch_scc1 L_e1
    s_mul_i32 s76, s60, 196608
    s_lshl_b32 s77, s61, 7
    s_add_u32 s76, s76, s77
    v_add3_u32 v10, v3, v2, s76
    s_lshl_b32 s77, s3, 10
    s_add_u32 m0, s77, 12288
    s_waitcnt lgkmcnt(0)
    global_load_dwordx4 v[20:23], v5, s[4:5]
    global_load_lds_dwordx4 v10, s[6:7]
    s_branch L_e3
L_e1:
    s_lshl2_add_u32 s76, s61, s3
    s_bfe_u32 s79, s76, 0x40001
    s_and_b32 s76, s76, 1
    s_lshl1_add_u32 s74, s60, s76
    s_lshl4_add_u32 s74, s74, s79
    s_lshl_b32 s74, s74, 9
    s_lshl3_add_u32 s76, s76, s60
    s_lshl_b32 s76, s76, 7
    s_lshl_b32 s77, s79, 2
    s_sub_u32 s77, s77, s3
    s_mul_i32 s77, s77, 49152
    s_add_u32 s76, s76, s77
    v_lshl_add_u32 v9, v3, 1, v2
    s_lshl_b32 s79, s79, 6
    v_and_b32 v13, 31, v0
    v_add_u32 v9, s76, v9
    v_lshl_add_u32 v13, v13, 1, s79
    s_lshl_b32 s77, s3, 12
    s_add_u32 m0, s77, 0
    s_waitcnt lgkmcnt(0)
    s_cmp_ge_u32 s3, 4
    s_cbranch_scc1 L_e2
    global_load_ushort v16, v13, s[16:17]
    global_load_lds_dwordx4 v9, s[18:19]
    s_add_u32 m0, s77, 1024
    v_add_u32 v9, 49152, v9
    global_load_lds_dwordx4 v9, s[18:19]
    s_add_u32 m0, s77, 2048
    v_add_u32 v9, 49152, v9
    global_load_lds_dwordx4 v9, s[18:19]
    s_add_u32 m0, s77, 3072
    v_add_u32 v9, 49152, v9
    global_load_lds_dwordx4 v9, s[18:19]
    v_and_b32 v1, 3, v0
    s_add_u32 s76, s74, 3932160
    v_lshl_add_u32 v1, v1, 7, s76
    global_load_dword v38, v1, s[24:25] sc1
L_e2:
    global_load_dwordx4 v[20:23], v5, s[4:5]
L_e3:
    s_load_dword s62, s[24:25], 0
    s_load_dwordx4 s[20:23], s[0:1], 64
    v_and_b32 v0, 63, v0
    s_mov_b32 s44, s24
    s_mov_b32 s45, s25
    s_mov_b32 s46, 28311552
    s_mov_b32 s47, 0x20000
    v_lshlrev_b32 v6, 4, v0
    v_lshrrev_b32 v7, 4, v0
    s_cmp_lg_u32 s3, 6
    s_cbranch_scc1 L_skip_2
    s_lshl_b32 s76, s2, 7
    s_add_u32 s76, s76, 65536
    s_mov_b32 s77, 27918336
    v_mul_lo_u32 v1, v0, s77
    s_mov_b64 exec, 3
    buffer_load_dword v39, v1, s[44:47], s76 offen sc1
    s_mov_b64 exec, -1
L_skip_2:
    s_mov_b32 s28, s4
    s_mov_b32 s29, s5
    s_mov_b32 s30, 2097152
    s_mov_b32 s31, 0x20000
    v_lshrrev_b32 v1, 3, v0
    v_and_b32 v2, 7, v0
    v_xor_b32 v2, v2, v7
    v_lshlrev_b32 v1, 10, v1
    v_lshl_add_u32 v11, v2, 4, v1
    v_xor_b32 v12, 64, v11
    s_lshl_b32 s77, s3, 15
    s_add_u32 s80, s80, s77
    s_lshl_b32 s81, s3, 13
    s_add_u32 s81, s81, 33792
    v_lshrrev_b32 v1, 1, v8
    v_xor_b32 v1, v1, v7
    v_lshlrev_b32 v1, 4, v1
    v_lshl_add_u32 v1, v8, 7, v1
    v_add_u32 v14, s81, v1
    v_xor_b32 v15, 64, v14
    s_lshr_b32 s63, s61, 3
    s_and_b32 s64, s61, 7
    s_lshl_b32 s65, s60, 21
    s_add_u32 s65, s65, 8388608
    s_lshr_b32 s27, s78, 6
    s_add_u32 s27, s27, 16384
    s_cmp_lt_u32 s61, 24
    s_cbranch_scc1 L_skip_3
    s_cmp_ge_u32 s3, 4
    s_cbranch_scc1 L_skip_4
    v_lshrrev_b32 v101, 5, v0
    v_bfe_u32 v102, v0, 2, 2
    v_lshl_add_u32 v102, v101, 3, v102
    s_lshl_b32 s76, s3, 12
    s_add_u32 s76, s76, 0
    v_lshl_add_u32 v102, v102, 7, s76
    v_and_b32 v100, 1, v7
    v_lshl_add_u32 v102, v100, 5, v102
    v_and_b32 v100, 3, v0
    v_lshl_add_u32 v102, v100, 3, v102
    s_lshl_b32 s76, s3, 7
    s_add_u32 s76, s76, 148480
    v_lshl_add_u32 v100, v0, 1, s76
    v_lshl_add_u32 v101, v101, 4, s76
L_skip_4:
L_skip_3:
    v_lshlrev_b32 v103, 3, v0
    s_waitcnt lgkmcnt(0)
    s_mul_i32 s62, s62, 0x41c64e6d
    s_add_u32 s62, s62, 0x3c6ef35f
    s_cmp_lt_u32 s61, 24
    s_cbranch_scc1 L_skip_5
    s_cmp_ge_u32 s3, 4
    s_cbranch_scc1 L_skip_6
    s_setprio 2
    s_waitcnt vmcnt(6)
    v_lshlrev_b32 v16, 16, v16
    v_mul_f32 v17, 0xbfb8aa3b, v16
    v_exp_f32 v17, v17
    s_nop 0
    v_add_f32 v17, 1.0, v17
    v_rcp_f32 v17, v17
    s_nop 0
    v_mul_f32 v16, v16, v17
    v_cvt_pk_bf16_f32 v16, v16, v16
    ds_write_b16 v100, v16
    ds_read_b128 v[40:43], v101
    ds_read_b128 v[44:47], v101 offset:32
    s_waitcnt vmcnt(2)
    ds_read_b64_tr_b16 v[48:49], v102 offset:0
    ds_read_b64_tr_b16 v[50:51], v102 offset:512
    ds_read_b64_tr_b16 v[52:53], v102 offset:64
    ds_read_b64_tr_b16 v[54:55], v102 offset:576
    ds_read_b64_tr_b16 v[56:57], v102 offset:2048
    ds_read_b64_tr_b16 v[58:59], v102 offset:2560
    ds_read_b64_tr_b16 v[60:61], v102 offset:2112
    ds_read_b64_tr_b16 v[62:63], v102 offset:2624
    s_waitcnt lgkmcnt(6)
    v_mfma_f32_32x32x16_bf16 v[64:79], v[40:43], v[48:51], 0
    s_waitcnt lgkmcnt(4)
    v_mfma_f32_32x32x16_bf16 v[80:95], v[40:43], v[52:55], 0
    s_waitcnt lgkmcnt(2)
    v_mfma_f32_32x32x16_bf16 v[64:79], v[44:47], v[56:59], v[64:79]
    s_waitcnt lgkmcnt(0)
    v_mfma_f32_32x32x16_bf16 v[80:95], v[44:47], v[60:63], v[80:95]
    s_add_u32 s77, s74, 3932160
    s_add_u32 s76, s74, 3538944
    v_mov_b32 v17, s62
    s_mov_b32 vcc_lo, 0
    s_mov_b32 vcc_hi, -1
    s_nop 6
    v_cndmask_b32 v16, v64, v80, vcc
    buffer_store_dwordx2 v[16:17], v103, s[44:47], s77 offen
    buffer_store_dwordx2 v[16:17], v103, s[44:47], s76 offen sc1
    s_setprio 0
L_skip_6:
L_skip_5:
    s_waitcnt vmcnt(1)
    s_add_u32 m0, s81, 0
    s_add_u32 s77, s80, 0
    buffer_load_dwordx4 v11, s[28:31], s77 offen  lds
    s_add_u32 m0, s81, 1024
    s_add_u32 s77, s80, 8192
    buffer_load_dwordx4 v12, s[28:31], s77 offen  lds
    s_add_u32 m0, s81, 2048
    s_add_u32 s77, s80, 16384
    buffer_load_dwordx4 v11, s[28:31], s77 offen  lds
    s_add_u32 m0, s81, 3072
    s_add_u32 s77, s80, 24576
    buffer_load_dwordx4 v12, s[28:31], s77 offen  lds
    s_add_u32 m0, s81, 4096
    s_add_u32 s77, s80, 128
    buffer_load_dwordx4 v11, s[28:31], s77 offen  lds
    s_add_u32 m0, s81, 5120
    s_add_u32 s77, s80, 8320
    buffer_load_dwordx4 v12, s[28:31], s77 offen  lds
    s_add_u32 m0, s81, 6144
    s_add_u32 s77, s80, 16512
    buffer_load_dwordx4 v11, s[28:31], s77 offen  lds
    s_add_u32 m0, s81, 7168
    s_add_u32 s77, s80, 24704
    buffer_load_dwordx4 v12, s[28:31], s77 offen  lds
    s_lshl_b32 s78, s3, 10
    s_add_u32 s78, s78, 150528
    s_and_b32 s77, s3, 1
    s_lshr_b32 s79, s3, 1
    s_lshl2_add_u32 s77, s77, s79
    s_lshl3_add_u32 s79, s60, s77
    s_lshl_b32 s79, s79, 11
    s_add_u32 s79, s79, 3932160
    s_lshl_b32 s77, s77, 9
    s_add_u32 s77, s77, 20480
    v_add_u32 v4, s77, v103
    v_and_b32 v1, 31, v0
    v_lshrrev_b32 v2, 5, v0
    v_xor_b32 v2, 1, v2
    v_lshl_add_u32 v1, v2, 8, v1
    v_lshlrev_b32 v13, 3, v1
    v_cvt_f32_u32 v36, v2
    v_add_u32 v5, 20480, v13
    s_lshr_b32 s76, s3, 2
    s_and_b32 s77, s3, 3
    s_lshl_b32 s73, s76, 12
    s_lshl_b32 s69, s77, 5
    s_add_u32 s73, s73, s69
    s_add_u32 s73, s73, 12288
    v_lshl_add_u32 v3, v7, 10, s73
    v_bfe_u32 v1, v0, 2, 2
    v_lshl_add_u32 v3, v1, 7, v3
    v_and_b32 v1, 3, v0
    v_lshl_add_u32 v3, v1, 3, v3
    v_add_u32 v104, s78, v103
    v_lshl_add_u32 v105, v0, 2, s78
    s_lshl_b32 s73, s76, 6
    s_add_u32 s69, s78, s73
    s_add_u32 s73, s69, s73
    v_lshl_add_u32 v106, v7, 5, s73
    v_and_b32 v2, 1, v0
    v_lshlrev_b32 v2, 7, v2
    v_lshl_add_u32 v2, v7, 4, v2
    v_add_u32 v107, s69, v2
    s_lshl2_add_u32 s73, s64, s77
    s_mul_i32 s69, s76, 3
    s_add_u32 s69, s69, s63
    s_lshl3_add_u32 s73, s73, s60
    s_mul_i32 s70, s73, 6
    s_add_u32 s70, s70, s69
    s_lshl_b32 s69, s70, 10
    s_add_u32 s69, s69, 26214400
    s_lshl_b32 s70, s70, 7
    s_add_u32 s70, s70, 27787264
    s_waitcnt vmcnt(6)
    ds_read_b128 v[128:131], v14 offset:0
    ds_read_b128 v[136:139], v15 offset:0
    s_waitcnt lgkmcnt(0)
    s_add_u32 m0, s81, 0
    s_add_u32 s77, s80, 256
    buffer_load_dwordx4 v11, s[28:31], s77 offen  lds
    s_add_u32 m0, s81, 1024
    s_add_u32 s77, s80, 8448
    buffer_load_dwordx4 v12, s[28:31], s77 offen  lds
    s_waitcnt vmcnt(6)
    ds_read_b128 v[132:135], v14 offset:2048
    ds_read_b128 v[140:143], v15 offset:2048
    s_waitcnt vmcnt(4)
    ds_read_b128 v[144:147], v14 offset:4096
    ds_read_b128 v[152:155], v15 offset:4096
    s_waitcnt vmcnt(2)
    ds_read_b128 v[148:151], v14 offset:6144
    ds_read_b128 v[156:159], v15 offset:6144
    s_waitcnt vmcnt(0)
    ds_read_b128 v[160:163], v14 offset:0
    ds_read_b128 v[168:171], v15 offset:0
    s_cmp_ge_u32 s61, 24
    s_cbranch_scc1 L_m2
    s_mov_b32 s67, 0
L_poll_7:
    buffer_load_dwordx4 v[24:27], v6, s[44:47], s79 offen sc1
    buffer_load_dwordx4 v[28:31], v6, s[44:47], s79 offen offset:1024 sc1
    s_add_u32 s67, s67, 1
    s_cmp_eq_u32 s67, 12
    s_cselect_b32 s76, 393216, 0
    s_sub_u32 s79, s79, s76
    s_cmp_ge_u32 s67, 0x40000
    s_cbranch_scc1 L_polld_8
    s_waitcnt vmcnt(0)
    v_cmp_ne_u32 vcc, s62, v25
    v_cmp_ne_u32 s[82:83], s62, v27
    s_nop 0
    s_or_b64 vcc, vcc, s[82:83]
    v_cmp_ne_u32 s[82:83], s62, v29
    s_nop 0
    s_or_b64 vcc, vcc, s[82:83]
    v_cmp_ne_u32 s[82:83], s62, v31
    s_nop 0
    s_or_b64 vcc, vcc, s[82:83]
    s_cbranch_vccnz L_poll_7
L_polld_8:
    s_waitcnt vmcnt(0)
    v_add_f32 v24, v24, v28
    v_add_f32 v25, v26, v30
    ds_write_b64 v4, v[24:25]
    s_waitcnt lgkmcnt(0)
    s_barrier
    ds_read2_b64 v[40:43], v5 offset0:0 offset1:32
    ds_read2_b64 v[44:47], v5 offset0:64 offset1:96
    ds_read2_b64 v[48:51], v5 offset0:128 offset1:160
    ds_read2_b64 v[52:55], v5 offset0:192 offset1:224
    ds_read_b64_tr_b16 v[56:57], v3
    ds_read_b64_tr_b16 v[58:59], v3 offset:512
    s_waitcnt lgkmcnt(5)
    v_pk_add_f32 v[40:41], v[40:41], v[42:43]
    s_waitcnt lgkmcnt(4)
    v_pk_add_f32 v[44:45], v[44:45], v[46:47]
    s_waitcnt lgkmcnt(3)
    v_pk_add_f32 v[48:49], v[48:49], v[50:51]
    s_waitcnt lgkmcnt(2)
    v_pk_add_f32 v[52:53], v[52:53], v[54:55]
    v_pk_add_f32 v[40:41], v[40:41], v[44:45]
    v_pk_add_f32 v[48:49], v[48:49], v[52:53]
    v_pk_add_f32 v[40:41], v[40:41], v[48:49]
    v_cvt_pk_bf16_f32 v16, v40, v41
    v_lshlrev_b32 v18, 16, v16
    v_and_b32 v19, 0xffff0000, v16
    v_add_f32 v18, v18, v36
    v_add_f32 v19, v19, v36
    v_cvt_pk_bf16_f32 v16, v18, v19
    v_and_b32 v18, 0xffff, v16
    v_and_b32 v19, 0xffff0000, v16
    ds_write_b64 v104, v[18:19]
    ds_write_b32 v105, v16 offset:512
    ds_read_b128 v[40:43], v106
    ds_read_b128 v[44:47], v106 offset:16
    ds_read_b128 v[60:63], v107 offset:512
    s_waitcnt lgkmcnt(2)
    v_dot2_f32_bf16 v24, v56, v40, 0
    v_dot2_f32_bf16 v25, v56, v41, 0
    v_dot2_f32_bf16 v26, v57, v42, 0
    v_dot2_f32_bf16 v27, v57, v43, 0
    s_waitcnt lgkmcnt(1)
    v_dot2_f32_bf16 v28, v58, v44, 0
    v_dot2_f32_bf16 v29, v58, v45, 0
    v_dot2_f32_bf16 v30, v59, v46, 0
    v_dot2_f32_bf16 v31, v59, v47, 0
    v_cvt_pk_bf16_f32 v32, v24, v25
    v_cvt_pk_bf16_f32 v33, v26, v27
    v_cvt_pk_bf16_f32 v34, v28, v29
    v_cvt_pk_bf16_f32 v35, v30, v31
    buffer_store_dwordx4 v[32:35], v6, s[44:47], s69 offen sc1
    s_waitcnt lgkmcnt(0)
    v_mfma_f32_16x16x32_bf16 v[48:51], v[60:63], v[56:59], 0
    s_mov_b64 exec, 0xffff
    s_nop 6
    buffer_store_dwordx2 v[48:49], v103, s[44:47], s70 offen sc1
    s_mov_b64 exec, -1
L_m2:
    s_waitcnt lgkmcnt(6)
    s_add_u32 m0, s81, 2048
    s_add_u32 s77, s80, 16640
    buffer_load_dwordx4 v11, s[28:31], s77 offen  lds
    s_add_u32 m0, s81, 3072
    s_add_u32 s77, s80, 24832
    buffer_load_dwordx4 v12, s[28:31], s77 offen  lds
    s_waitcnt lgkmcnt(4)
    s_add_u32 m0, s81, 4096
    s_add_u32 s77, s80, 384
    buffer_load_dwordx4 v11, s[28:31], s77 offen  lds
    s_add_u32 m0, s81, 5120
    s_add_u32 s77, s80, 8576
    buffer_load_dwordx4 v12, s[28:31], s77 offen  lds
    v_lshlrev_b32 v24, 16, v20
    v_and_b32 v25, 0xffff0000, v20
    v_lshlrev_b32 v26, 16, v21
    v_and_b32 v27, 0xffff0000, v21
    v_lshlrev_b32 v28, 16, v22
    v_and_b32 v29, 0xffff0000, v22
    v_lshlrev_b32 v30, 16, v23
    v_and_b32 v31, 0xffff0000, v23
    v_pk_add_f32 v[32:33], v[24:25], v[26:27]
    v_pk_add_f32 v[34:35], v[28:29], v[30:31]
    v_pk_add_f32 v[32:33], v[32:33], v[34:35]
    v_add_f32 v32, v32, v33
    s_nop 1
    v_add_f32_dpp v32, v32, v32 row_shr:1 row_mask:0xf bank_mask:0xf
    s_nop 1
    v_add_f32_dpp v32, v32, v32 row_shr:2 row_mask:0xf bank_mask:0xf
    s_nop 1
    v_add_f32_dpp v32, v32, v32 row_shr:4 row_mask:0xf bank_mask:0xf
    s_nop 1
    v_add_f32_dpp v32, v32, v32 row_shr:8 row_mask:0xf bank_mask:0xf
    s_nop 1
    v_add_f32_dpp v32, v32, v32 row_bcast:15 row_mask:0xa bank_mask:0xf
    s_nop 1
    v_add_f32_dpp v32, v32, v32 row_bcast:31 row_mask:0xc bank_mask:0xf
    v_mul_f32 v32, 0x3b000000, v32
    s_nop 0
    v_readlane_b32 s76, v32, 63
    s_nop 1
    v_subrev_f32 v24, s76, v24
    v_subrev_f32 v25, s76, v25
    v_subrev_f32 v26, s76, v26
    v_subrev_f32 v27, s76, v27
    v_subrev_f32 v28, s76, v28
    v_subrev_f32 v29, s76, v29
    v_subrev_f32 v30, s76, v30
    v_subrev_f32 v31, s76, v31
    v_mul_f32 v33, v24, v24
    v_fmac_f32 v33, v25, v25
    v_fmac_f32 v33, v26, v26
    v_fmac_f32 v33, v27, v27
    v_fmac_f32 v33, v28, v28
    v_fmac_f32 v33, v29, v29
    v_fmac_f32 v33, v30, v30
    v_fmac_f32 v33, v31, v31
    s_nop 1
    v_add_f32_dpp v33, v33, v33 row_shr:1 row_mask:0xf bank_mask:0xf
    s_nop 1
    v_add_f32_dpp v33, v33, v33 row_shr:2 row_mask:0xf bank_mask:0xf
    s_nop 1
    v_add_f32_dpp v33, v33, v33 row_shr:4 row_mask:0xf bank_mask:0xf
    s_nop 1
    v_add_f32_dpp v33, v33, v33 row_shr:8 row_mask:0xf bank_mask:0xf
    s_nop 1
    v_add_f32_dpp v33, v33, v33 row_bcast:15 row_mask:0xa bank_mask:0xf
    s_nop 1
    v_add_f32_dpp v33, v33, v33 row_bcast:31 row_mask:0xc bank_mask:0xf
    v_mov_b32 v34, 0x3727c5ac
    v_fmac_f32 v34, 0x3b000000, v33
    v_rsq_f32 v34, v34
    s_getreg_b32 s76, hwreg(HW_REG_XCC_ID, 0, 4)
    s_xor_b32 s76, s76, s62
    v_mov_b32 v33, s62
    v_mov_b32 v35, s76
    s_lshl_b32 s76, s3, 4
    s_add_u32 s76, s76, 149504
    v_mov_b32 v1, s76
    s_mov_b32 exec_lo, 0
    s_mov_b32 exec_hi, 0x80000000
    ds_write_b128 v1, v[32:35]
    s_mov_b64 exec, -1
    s_waitcnt vmcnt(4)
    s_waitcnt lgkmcnt(0)
    s_barrier
    s_cmp_lg_u32 s3, 0
    s_cbranch_scc1 L_skip_9
    s_lshl_b32 s76, s2, 7
    s_add_u32 s76, s76, 27983872
    v_mov_b32 v16, s62
    v_mov_b32 v17, s62
    s_mov_b64 exec, 0xffff
    buffer_store_dwordx2 v[16:17], v103, s[44:47], s76 offen sc1
    s_mov_b64 exec, -1
    v_add_u32 v1, 149504, v6
    ds_read_b128 v[16:19], v1
    s_mov_b64 exec, 0xff
    s_waitcnt lgkmcnt(0)
    buffer_store_dwordx4 v[16:19], v6, s[44:47], s27 offen sc1
    s_mov_b64 exec, -1
L_skip_9:
    s_add_u32 m0, s81, 6144
    s_add_u32 s77, s80, 16768
    buffer_load_dwordx4 v11, s[28:31], s77 offen  lds
    s_add_u32 m0, s81, 7168
    s_add_u32 s77, s80, 24960
    buffer_load_dwordx4 v12, s[28:31], s77 offen  lds
    s_add_u32 m0, s81, 0
    s_add_u32 s77, s80, 512
    buffer_load_dwordx4 v11, s[28:31], s77 offen  lds
    s_add_u32 m0, s81, 1024
    s_add_u32 s77, s80, 8704
    buffer_load_dwordx4 v12, s[28:31], s77 offen  lds
    s_waitcnt vmcnt(6)
    ds_read_b128 v[164:167], v14 offset:2048
    ds_read_b128 v[172:175], v15 offset:2048
    s_waitcnt lgkmcnt(0)
    s_add_u32 m0, s81, 2048
    s_add_u32 s77, s80, 16896
    buffer_load_dwordx4 v11, s[28:31], s77 offen  lds
    s_add_u32 m0, s81, 3072
    s_add_u32 s77, s80, 25088
    buffer_load_dwordx4 v12, s[28:31], s77 offen  lds
    s_waitcnt vmcnt(6)
    ds_read_b128 v[176:179], v14 offset:4096
    ds_read_b128 v[184:187], v15 offset:4096
    s_waitcnt lgkmcnt(0)
    s_add_u32 m0, s81, 4096
    s_add_u32 s77, s80, 640
    buffer_load_dwordx4 v11, s[28:31], s77 offen  lds
    s_add_u32 m0, s81, 5120
    s_add_u32 s77, s80, 8832
    buffer_load_dwordx4 v12, s[28:31], s77 offen  lds
    s_waitcnt vmcnt(6)
    ds_read_b128 v[180:183], v14 offset:6144
    ds_read_b128 v[188:191], v15 offset:6144
    s_waitcnt lgkmcnt(0)
    s_add_u32 m0, s81, 6144
    s_add_u32 s77, s80, 17024
    buffer_load_dwordx4 v11, s[28:31], s77 offen  lds
    s_add_u32 m0, s81, 7168
    s_add_u32 s77, s80, 25216
    buffer_load_dwordx4 v12, s[28:31], s77 offen  lds
    s_waitcnt vmcnt(6)
    ds_read_b128 v[192:195], v14 offset:0
    ds_read_b128 v[200:203], v15 offset:0
    s_waitcnt lgkmcnt(0)
    s_add_u32 m0, s81, 0
    s_add_u32 s77, s80, 768
    buffer_load_dwordx4 v11, s[28:31], s77 offen  lds
    s_add_u32 m0, s81, 1024
    s_add_u32 s77, s80, 8960
    buffer_load_dwordx4 v12, s[28:31], s77 offen  lds
    s_waitcnt vmcnt(6)
    ds_read_b128 v[196:199], v14 offset:2048
    ds_read_b128 v[204:207], v15 offset:2048
    s_waitcnt lgkmcnt(0)
    s_add_u32 m0, s81, 2048
    s_add_u32 s77, s80, 17152
    buffer_load_dwordx4 v11, s[28:31], s77 offen  lds
    s_add_u32 m0, s81, 3072
    s_add_u32 s77, s80, 25344
    buffer_load_dwordx4 v12, s[28:31], s77 offen  lds
    s_lshl_b32 s79, s60, 12
    s_lshl_b32 s77, s3, 9
    s_add_u32 s79, s79, s77
    s_add_u32 s79, s79, 16384
    v_and_b32 v4, 0x1f0, v6
    s_lshl4_add_u32 s26, s61, s3
    s_mul_i32 s69, s26, 3072
    s_add_u32 s69, s69, 26214400
    s_mul_i32 s70, s26, 384
    s_add_u32 s70, s70, 27787264
    s_lshr_b32 s76, s61, 2
    s_lshr_b32 s77, s3, 1
    s_lshl3_add_u32 s26, s76, s77
    s_lshl_b32 s26, s26, 7
    s_add_u32 s26, s26, 27983872
    s_mul_i32 s73, s3, 3072
    v_and_b32 v3, 3, v0
    v_min_u32 v3, 2, v3
    v_bfe_u32 v1, v0, 2, 1
    v_lshlrev_b32 v1, 9, v1
    v_lshl_add_u32 v3, v3, 13, v1
    buffer_load_dword v16, v3, s[44:47], s26 offen sc1
    s_waitcnt vmcnt(7)
    ds_read_b128 v[208:211], v14 offset:4096
    ds_read_b128 v[216:219], v15 offset:4096
    s_waitcnt vmcnt(5)
    ds_read_b128 v[212:215], v14 offset:6144
    ds_read_b128 v[220:223], v15 offset:6144
    s_waitcnt vmcnt(3)
    ds_read_b128 v[224:227], v14 offset:0
    ds_read_b128 v[232:235], v15 offset:0
    s_waitcnt vmcnt(1)
    ds_read_b128 v[228:231], v14 offset:2048
    ds_read_b128 v[236:239], v15 offset:2048
    s_waitcnt vmcnt(0)
    v_cmp_ne_u32 vcc, s62, v16
    s_nop 0
    s_cbranch_vccnz L_again_11
L_ok_10:
    s_add_u32 m0, s73, 99328
    s_nop 0
    buffer_load_dwordx4 v6, s[44:47], s69 offen offset:1024 sc1 lds
    buffer_load_dwordx4 v6, s[44:47], s69 offen offset:2048 sc1 lds
    buffer_load_dwordx2 v[16:17], v103, s[44:47], s70 offen sc1
    buffer_load_dwordx2 v[18:19], v103, s[44:47], s70 offen offset:3072 sc1
    buffer_load_dwordx4 v[120:123], v4, s[44:47], s79 offen sc1
    s_add_u32 s70, s69, 24576
    s_barrier
    s_add_u32 m0, s73, 123904
    s_nop 0
    buffer_load_dwordx4 v6, s[44:47], s70 offen offset:1024 sc1 lds
    buffer_load_dwordx4 v6, s[44:47], s70 offen offset:2048 sc1 lds
    s_mov_b32 s55, 0x20000
    s_mov_b64 s[52:53], s[8:9]
    s_mov_b32 s54, 524288
    s_lshl3_add_u32 s71, s2, s3
    s_mov_b32 s66, s81
    v_lshrrev_b32 v94, 2, v0
    v_and_b32 v1, 0x30, v6
    v_and_b32 v2, 3, v0
    v_lshl_add_u32 v95, v2, 3, s66
    v_bfe_u32 v2, v0, 2, 2
    s_cmp_ge_u32 s2, 86
    s_cbranch_scc1 L_pf_n1
    s_mov_b64 s[52:53], s[12:13]
    s_mov_b32 s54, 1409024
    s_movk_i32 s76, 2752
    v_mad_u32_u24 v94, v94, s76, v1
    s_mul_i32 s76, s71, 1525
    s_lshr_b32 s76, s76, 16
    s_mul_i32 s77, s76, 43
    s_sub_u32 s77, s71, s77
    s_lshl_b32 s72, s77, 15
    s_lshl_b32 s40, s76, 10
    s_add_u32 s72, s72, s40
    s_add_u32 s72, s72, 655360
    s_add_u32 s40, s72, 16384
    s_mul_i32 s76, s76, 88064
    s_lshl_b32 s77, s77, 6
    s_add_u32 s76, s76, s77
    s_add_u32 s77, s76, 44032
    v_lshl_add_u32 v95, v2, 6, v95
    v_lshl_add_u32 v95, v7, 9, v95
    s_movk_i32 s26, 256
    s_movk_i32 s75, 32
    s_branch L_pf_go
L_pf_n1:
    s_cmp_lt_u32 s2, 118
    s_cbranch_scc1 L_pf_n2
    s_mov_b64 s[52:53], s[14:15]
    s_mov_b32 s54, 1409024
    v_lshl_add_u32 v94, v94, 10, v1
    s_sub_u32 s77, s71, 944
    s_lshr_b32 s76, s77, 4
    s_and_b32 s77, s77, 15
    s_mul_i32 s72, s77, 88064
    s_lshl_b32 s40, s76, 10
    s_add_u32 s72, s72, s40
    s_add_u32 s72, s72, 2097152
    s_add_u32 s40, s72, 44032
    s_lshl_b32 s76, s76, 15
    s_lshl_b32 s77, s77, 6
    s_add_u32 s76, s76, s77
    s_add_u32 s77, s76, 16384
    v_lshl_add_u32 v95, v2, 6, v95
    v_lshl_add_u32 v95, v7, 9, v95
    s_movk_i32 s26, 256
    s_movk_i32 s75, 32
    s_branch L_pf_go
L_pf_n2:
    v_lshl_add_u32 v94, v94, 10, v1
    s_sub_u32 s77, s71, 688
    s_lshr_b32 s76, s77, 4
    s_and_b32 s77, s77, 15
    s_lshl_b32 s72, s77, 15
    s_lshl_b32 s40, s76, 10
    s_add_u32 s72, s72, s40
    s_add_u32 s72, s72, 131072
    s_add_u32 s40, s72, 16384
    s_lshl_b32 s76, s76, 15
    s_lshl_b32 s77, s77, 6
    s_add_u32 s76, s76, s77
    s_add_u32 s77, s76, 16384
    v_lshl_add_u32 v95, v2, 6, v95
    v_lshrrev_b32 v2, 5, v0
    v_lshl_add_u32 v95, v2, 10, v95
    v_and_b32 v2, 1, v7
    v_lshl_add_u32 v95, v2, 8, v95
    s_movk_i32 s26, 512
    s_movk_i32 s75, 32
L_pf_go:
    s_mov_b32 s10, s76
    s_mov_b32 s11, s77
    s_cmp_lt_u32 s2, 204
    s_cselect_b32 s72, s72, 28311552
    s_cselect_b32 s40, s40, 28311552
    v_bfe_u32 v1, v0, 2, 2
    v_bfe_u32 v2, v0, 4, 1
    v_lshl_add_u32 v1, v1, 1, v2
    v_and_b32 v2, 0x23, v0
    v_lshl_add_u32 v1, v1, 2, v2
    v_lshlrev_b32 v10, 4, v1
    s_mul_i32 s74, s3, 2064
    v_add_u32 v126, s74, v10
    v_add_u32 v127, s74, v6
    v_mov_b32 v3, v6
    v_lshrrev_b32 v1, 5, v0
    v_lshlrev_b32 v1, 8, v1
    v_add_u32 v2, 1024, v1
    v_lshl_add_u32 v2, v8, 4, v2
    v_mov_b32 v1, 0x40000
    s_mov_b32 vcc_lo, 0xfffe0000
    s_mov_b32 vcc_hi, 0xfffe0000
    v_cndmask_b32 v2, v2, v1, vcc
    v_add_u32 v5, 512, v2
    v_mov_b32 v1, 2048
    s_mov_b32 vcc_lo, 0x00010000
    s_mov_b32 vcc_hi, 0x00010000
    v_cndmask_b32 v99, v2, v1, vcc
    v_cndmask_b32 v5, v5, v1, vcc
    v_mov_b32 v2, 0xdddddddd
    v_add_u32 v9, 99328, v6
    v_add_u32 v100, 158720, v103
    s_lshl_b32 s76, s3, 9
    v_add_u32 v101, s76, v100
    s_mov_b32 s48, s20
    s_mov_b32 s49, s21
    s_mov_b32 s50, 2097152
    s_mov_b32 s51, 0x20000
    s_waitcnt vmcnt(3)
    v_pk_add_f32 v[16:17], v[16:17], v[18:19]
    ds_write_b64 v101, v[16:17]
    s_waitcnt vmcnt(2)
    v_cmp_ne_u32 vcc, s62, v121
    v_xor_b32 v1, s62, v123
    v_cmp_lt_u32 s[82:83], 15, v1
    s_nop 0
    s_or_b64 vcc, vcc, s[82:83]
    s_cbranch_vccnz L_again_15
L_ok_14:
    s_getreg_b32 s76, hwreg(HW_REG_XCC_ID, 0, 4)
    s_xor_b32 s76, s76, s62
    v_cmp_ne_u32 vcc, s76, v123
    v_mul_f32 v120, -v120, v122
    v_and_b32 v1, 31, v0
    v_lshl_add_u32 v1, v1, 2, s78
    s_or_b32 s76, vcc_lo, vcc_hi
    ds_write_b32 v1, v122 offset:512
    ds_write_b32 v1, v120 offset:640
    v_mov_b32 v121, s76
    s_lshl2_add_u32 s76, s3, 148480
    v_mov_b32 v1, s76
    ds_write_b32 v1, v121
    v_mov_b32 v1, 149760
    v_mov_b32 v4, 0
    ds_write_b32 v1, v4
    v_mov_b32 v4, v99
    s_waitcnt lgkmcnt(0)
    s_barrier
    s_setprio 3
    ds_read_b128 v[56:59], v9 offset:1024
    ds_read_b128 v[60:63], v9 offset:2048
    ds_read_b128 v[64:67], v9 offset:4096
    ds_read_b128 v[68:71], v9 offset:5120
    ds_read_b128 v[72:75], v9 offset:7168
    ds_read_b128 v[76:79], v9 offset:8192
    s_waitcnt lgkmcnt(5)
    v_mfma_f32_16x16x32_bf16 v[16:19], v[56:59], v[128:131], 0
    v_mfma_f32_16x16x32_bf16 v[20:23], v[56:59], v[132:135], 0
    ds_read_b128 v[80:83], v9 offset:10240
    s_waitcnt lgkmcnt(5)
    v_mfma_f32_16x16x32_bf16 v[24:27], v[128:131], v[60:63], 0
    v_mfma_f32_16x16x32_bf16 v[28:31], v[132:135], v[60:63], 0
    ds_read_b128 v[84:87], v9 offset:11264
    ds_read_b64 v[40:41], v100 offset:0
    ds_read_b64 v[42:43], v100 offset:512
    ds_read_b64 v[44:45], v100 offset:1024
    ds_read_b64 v[46:47], v100 offset:1536
    ds_read_b64 v[48:49], v100 offset:2048
    ds_read_b64 v[50:51], v100 offset:2560
    ds_read_b64 v[52:53], v100 offset:3072
    ds_read_b64 v[54:55], v100 offset:3584
    s_add_u32 m0, s81, 4096
    s_add_u32 s68, s80, 896
    buffer_load_dwordx4 v11, s[28:31], s68 offen  lds
    s_waitcnt lgkmcnt(13)
    v_mfma_f32_16x16x32_bf16 v[16:19], v[64:67], v[136:139], v[16:19]
    v_mfma_f32_16x16x32_bf16 v[20:23], v[64:67], v[140:143], v[20:23]
    ds_read_b128 v[56:59], v9 offset:13312
    s_waitcnt lgkmcnt(13)
    v_mfma_f32_16x16x32_bf16 v[24:27], v[136:139], v[68:71], v[24:27]
    v_mfma_f32_16x16x32_bf16 v[28:31], v[140:143], v[68:71], v[28:31]
    ds_read_b128 v[60:63], v9 offset:14336
    s_add_u32 m0, s81, 5120
    s_add_u32 s68, s80, 9088
    buffer_load_dwordx4 v12, s[28:31], s68 offen  lds
    s_waitcnt lgkmcnt(13)
    v_mfma_f32_16x16x32_bf16 v[16:19], v[72:75], v[144:147], v[16:19]
    v_mfma_f32_16x16x32_bf16 v[20:23], v[72:75], v[148:151], v[20:23]
    ds_read_b128 v[64:67], v9 offset:16384
    s_waitcnt lgkmcnt(13)
    v_mfma_f32_16x16x32_bf16 v[24:27], v[144:147], v[76:79], v[24:27]
    v_mfma_f32_16x16x32_bf16 v[28:31], v[148:151], v[76:79], v[28:31]
    ds_read_b128 v[68:71], v9 offset:17408
    s_waitcnt lgkmcnt(10)
    v_add_f32 v40, v40, v42
    v_add_f32 v41, v41, v43
    s_waitcnt lgkmcnt(8)
    v_add_f32 v44, v44, v46
    v_add_f32 v45, v45, v47
    s_waitcnt lgkmcnt(6)
    v_add_f32 v48, v48, v50
    v_add_f32 v49, v49, v51
    s_waitcnt lgkmcnt(4)
    v_add_f32 v52, v52, v54
    v_add_f32 v53, v53, v55
    v_add_f32 v40, v40, v44
    v_add_f32 v41, v41, v45
    v_add_f32 v48, v48, v52
    v_add_f32 v49, v49, v53
    v_add_f32 v40, v40, v48
    v_add_f32 v41, v41, v49
    ds_write_b32 v105, v40
    ds_write_b32 v105, v41 offset:256
    s_add_u32 m0, s81, 6144
    s_add_u32 s68, s80, 17280
    buffer_load_dwordx4 v11, s[28:31], s68 offen  lds
    v_mfma_f32_16x16x32_bf16 v[16:19], v[80:83], v[152:155], v[16:19]
    v_mfma_f32_16x16x32_bf16 v[20:23], v[80:83], v[156:159], v[20:23]
    ds_read_b128 v[72:75], v9 offset:19456
    v_mfma_f32_16x16x32_bf16 v[24:27], v[152:155], v[84:87], v[24:27]
    v_mfma_f32_16x16x32_bf16 v[28:31], v[156:159], v[84:87], v[28:31]
    ds_read_b128 v[76:79], v9 offset:20480
    v_lshl_add_u32 v100, v7, 4, s78
    v_lshl_add_u32 v101, v8, 2, s78
    ds_read_b128 v[40:43], v100 offset:64
    ds_read_b128 v[104:107], v100 offset:320
    ds_read2_b32 v[120:121], v101 offset0:128 offset1:160
    ds_read2_b32 v[122:123], v101 offset0:144 offset1:176
    s_add_u32 m0, s81, 7168
    s_add_u32 s68, s80, 25472
    buffer_load_dwordx4 v12, s[28:31], s68 offen  lds
    s_add_u32 m0, s73, 99328
    s_nop 0
    buffer_load_dwordx4 v6, s[44:47], s69 offen sc1 lds
    s_waitcnt lgkmcnt(11)
    v_mfma_f32_16x16x32_bf16 v[16:19], v[56:59], v[160:163], v[16:19]
    v_mfma_f32_16x16x32_bf16 v[20:23], v[56:59], v[164:167], v[20:23]
    ds_read_b128 v[80:83], v9 offset:22528
    s_waitcnt lgkmcnt(11)
    v_mfma_f32_16x16x32_bf16 v[24:27], v[160:163], v[60:63], v[24:27]
    v_mfma_f32_16x16x32_bf16 v[28:31], v[164:167], v[60:63], v[28:31]
    ds_read_b128 v[84:87], v9 offset:23552
    s_add_u32 m0, s73, 123904
    s_nop 0
    buffer_load_dwordx4 v6, s[44:47], s70 offen sc1 lds
    s_waitcnt vmcnt(6)
    s_barrier
    s_waitcnt lgkmcnt(11)
    v_mfma_f32_16x16x32_bf16 v[16:19], v[64:67], v[168:171], v[16:19]
    v_mfma_f32_16x16x32_bf16 v[20:23], v[64:67], v[172:175], v[20:23]
    ds_read_b128 v[56:59], v9 offset:25600
    s_waitcnt lgkmcnt(11)
    v_mfma_f32_16x16x32_bf16 v[24:27], v[168:171], v[68:71], v[24:27]
    v_mfma_f32_16x16x32_bf16 v[28:31], v[172:175], v[68:71], v[28:31]
    ds_read_b128 v[60:63], v9 offset:26624
    ds_read_b128 v[48:51], v100
    ds_read_b128 v[108:111], v100 offset:256
    ds_read2_b32 v[124:125], v101 offset0:32 offset1:96
    ds_read_b128 v[112:115], v100 offset:640
    ds_read_b128 v[116:119], v100 offset:704
    s_mov_b32 m0, s66
    s_nop 0
    buffer_load_dwordx4 v94, s[52:55], s10 offen  lds
    s_add_u32 m0, s66, 1024
    s_nop 0
    buffer_load_dwordx4 v94, s[52:55], s11 offen  lds
    s_waitcnt lgkmcnt(14)
    v_mfma_f32_16x16x32_bf16 v[16:19], v[72:75], v[176:179], v[16:19]
    v_mfma_f32_16x16x32_bf16 v[20:23], v[72:75], v[180:183], v[20:23]
    ds_read_b128 v[64:67], v9 offset:28672
    s_waitcnt lgkmcnt(14)
    v_mfma_f32_16x16x32_bf16 v[24:27], v[176:179], v[76:79], v[24:27]
    v_mfma_f32_16x16x32_bf16 v[28:31], v[180:183], v[76:79], v[28:31]
    ds_read_b128 v[68:71], v9 offset:29696
    s_waitcnt lgkmcnt(11)
    v_fma_f32 v44, v123, v40, v104
    v_fma_f32 v40, v121, v40, v104
    v_fma_f32 v45, v123, v41, v105
    v_fma_f32 v41, v121, v41, v105
    v_fma_f32 v46, v123, v42, v106
    v_fma_f32 v42, v121, v42, v106
    v_fma_f32 v47, v123, v43, v107
    v_fma_f32 v43, v121, v43, v107
    s_waitcnt lgkmcnt(10)
    v_mfma_f32_16x16x32_bf16 v[16:19], v[80:83], v[184:187], v[16:19]
    v_mfma_f32_16x16x32_bf16 v[20:23], v[80:83], v[188:191], v[20:23]
    ds_read_b128 v[72:75], v9 offset:31744
    s_waitcnt lgkmcnt(10)
    v_mfma_f32_16x16x32_bf16 v[24:27], v[184:187], v[84:87], v[24:27]
    v_mfma_f32_16x16x32_bf16 v[28:31], v[188:191], v[84:87], v[28:31]
    ds_read_b128 v[76:79], v9 offset:32768
    s_waitcnt lgkmcnt(10)
    v_mfma_f32_16x16x32_bf16 v[16:19], v[56:59], v[192:195], v[16:19]
    v_mfma_f32_16x16x32_bf16 v[20:23], v[56:59], v[196:199], v[20:23]
    ds_read_b128 v[80:83], v9 offset:34816
    s_waitcnt lgkmcnt(10)
    v_mfma_f32_16x16x32_bf16 v[24:27], v[192:195], v[60:63], v[24:27]
    v_mfma_f32_16x16x32_bf16 v[28:31], v[196:199], v[60:63], v[28:31]
    ds_read_b128 v[84:87], v9 offset:35840
    s_waitcnt lgkmcnt(9)
    v_fma_f32 v52, v123, v48, v108
    v_fma_f32 v48, v121, v48, v108
    v_fma_f32 v53, v123, v49, v109
    v_fma_f32 v49, v121, v49, v109
    v_fma_f32 v54, v123, v50, v110
    v_fma_f32 v50, v121, v50, v110
    v_fma_f32 v55, v123, v51, v111
    v_fma_f32 v51, v121, v51, v111
    ds_read_b128 v[104:107], v100 offset:512
    ds_read_b128 v[108:111], v100 offset:576
    s_waitcnt lgkmcnt(7)
    v_mfma_f32_16x16x32_bf16 v[16:19], v[64:67], v[200:203], v[16:19]
    v_mfma_f32_16x16x32_bf16 v[20:23], v[64:67], v[204:207], v[20:23]
    ds_read_b128 v[56:59], v9 offset:37888
    s_waitcnt lgkmcnt(7)
    v_mfma_f32_16x16x32_bf16 v[24:27], v[200:203], v[68:71], v[24:27]
    v_mfma_f32_16x16x32_bf16 v[28:31], v[204:207], v[68:71], v[28:31]
    ds_read_b128 v[60:63], v9 offset:38912
    s_mov_b32 s79, s74
    s_lshl_b32 s68, s61, 17
    s_add_u32 s68, s68, 4194304
    s_lshl3_add_u32 s80, s60, s3
    s_lshl_b32 s80, s80, 11
    s_add_u32 s80, s80, s68
    s_lshl_b32 s76, s2, 7
    s_add_u32 s81, s76, 65536
    s_waitcnt lgkmcnt(7)
    v_mfma_f32_16x16x32_bf16 v[16:19], v[72:75], v[208:211], v[16:19]
    v_mfma_f32_16x16x32_bf16 v[20:23], v[72:75], v[212:215], v[20:23]
    ds_read_b128 v[64:67], v9 offset:40960
    s_waitcnt lgkmcnt(7)
    v_mfma_f32_16x16x32_bf16 v[24:27], v[208:211], v[76:79], v[24:27]
    v_mfma_f32_16x16x32_bf16 v[28:31], v[212:215], v[76:79], v[28:31]
    ds_read_b128 v[68:71], v9 offset:41984
    v_fma_f32 v112, v112, v124, v125
    v_fma_f32 v113, v113, v124, v125
    v_fma_f32 v114, v114, v124, v125
    v_fma_f32 v115, v115, v124, v125
    v_fma_f32 v116, v116, v124, v125
    v_fma_f32 v117, v117, v124, v125
    v_fma_f32 v118, v118, v124, v125
    v_fma_f32 v119, v119, v124, v125
    s_waitcnt lgkmcnt(7)
    v_mfma_f32_16x16x32_bf16 v[16:19], v[80:83], v[216:219], v[16:19]
    v_mfma_f32_16x16x32_bf16 v[20:23], v[80:83], v[220:223], v[20:23]
    ds_read_b128 v[72:75], v9 offset:44032
    s_waitcnt lgkmcnt(7)
    v_mfma_f32_16x16x32_bf16 v[24:27], v[216:219], v[84:87], v[24:27]
    v_mfma_f32_16x16x32_bf16 v[28:31], v[220:223], v[84:87], v[28:31]
    ds_read_b128 v[76:79], v9 offset:45056
    s_waitcnt vmcnt(6)
    ds_read_b128 v[240:243], v14 offset:4096
    ds_read_b128 v[248:251], v15 offset:4096
    s_waitcnt lgkmcnt(7)
    v_mfma_f32_16x16x32_bf16 v[16:19], v[56:59], v[224:227], v[16:19]
    v_mfma_f32_16x16x32_bf16 v[20:23], v[56:59], v[228:231], v[20:23]
    ds_read_b128 v[80:83], v9 offset:47104
    s_waitcnt lgkmcnt(7)
    v_mfma_f32_16x16x32_bf16 v[24:27], v[224:227], v[60:63], v[24:27]
    v_mfma_f32_16x16x32_bf16 v[28:31], v[228:231], v[60:63], v[28:31]
    ds_read_b128 v[84:87], v9 offset:48128
    v_mul_f32 v48, 0x3eb8aa3b, v48
    v_mul_f32 v49, 0x3eb8aa3b, v49
    v_mul_f32 v50, 0x3eb8aa3b, v50
    v_mul_f32 v51, 0x3eb8aa3b, v51
    v_mul_f32 v52, 0x3eb8aa3b, v52
    v_mul_f32 v53, 0x3eb8aa3b, v53
    v_mul_f32 v54, 0x3eb8aa3b, v54
    v_mul_f32 v55, 0x3eb8aa3b, v55
    v_mul_f32 v121, 0x3eb8aa3b, v120
    v_mul_f32 v123, 0x3eb8aa3b, v122
    s_waitcnt vmcnt(4)
    ds_read_b128 v[244:247], v14 offset:6144
    ds_read_b128 v[252:255], v15 offset:6144
    s_waitcnt vmcnt(2)
    s_barrier
    s_waitcnt lgkmcnt(9)
    v_mfma_f32_16x16x32_bf16 v[16:19], v[64:67], v[232:235], v[16:19]
    v_mfma_f32_16x16x32_bf16 v[20:23], v[64:67], v[236:239], v[20:23]
    s_waitcnt lgkmcnt(8)
    v_mfma_f32_16x16x32_bf16 v[24:27], v[232:235], v[68:71], v[24:27]
    v_mfma_f32_16x16x32_bf16 v[28:31], v[236:239], v[68:71], v[28:31]
    s_waitcnt lgkmcnt(5)
    v_mfma_f32_16x16x32_bf16 v[16:19], v[72:75], v[240:243], v[16:19]
    s_waitcnt lgkmcnt(1)
    v_mfma_f32_16x16x32_bf16 v[20:23], v[72:75], v[244:247], v[20:23]
    ds_read_b128 v[56:59], v9 offset:0
    v_mfma_f32_16x16x32_bf16 v[24:27], v[240:243], v[76:79], v[24:27]
    v_mfma_f32_16x16x32_bf16 v[28:31], v[244:247], v[76:79], v[28:31]
    ds_read_b128 v[60:63], v9 offset:3072
    v_mfma_f32_16x16x32_bf16 v[16:19], v[80:83], v[248:251], v[16:19]
    s_waitcnt lgkmcnt(2)
    v_mfma_f32_16x16x32_bf16 v[20:23], v[80:83], v[252:255], v[20:23]
    ds_read_b128 v[64:67], v9 offset:6144
    v_mfma_f32_16x16x32_bf16 v[24:27], v[248:251], v[84:87], v[24:27]
    v_mfma_f32_16x16x32_bf16 v[28:31], v[252:255], v[84:87], v[28:31]
    ds_read_b128 v[68:71], v9 offset:9216
    s_nop 1
    v_fma_f32 v16, v120, v16, v40
    v_fma_f32 v17, v120, v17, v41
    v_fma_f32 v18, v120, v18, v42
    v_fma_f32 v19, v120, v19, v43
    v_fma_f32 v20, v122, v20, v44
    v_fma_f32 v21, v122, v21, v45
    v_fma_f32 v22, v122, v22, v46
    v_fma_f32 v23, v122, v23, v47
    v_cvt_pk_bf16_f32 v40, v16, v17
    v_cvt_pk_bf16_f32 v41, v18, v19
    v_cvt_pk_bf16_f32 v42, v20, v21
    v_cvt_pk_bf16_f32 v43, v22, v23
    v_fma_f32 v24, v104, v24, v112
    v_fma_f32 v25, v105, v25, v113
    v_fma_f32 v26, v106, v26, v114
    v_fma_f32 v27, v107, v27, v115
    v_fma_f32 v28, v108, v28, v116
    v_fma_f32 v29, v109, v29, v117
    v_fma_f32 v30, v110, v30, v118
    v_fma_f32 v31, v111, v31, v119
    v_permlane16_swap_b32 v40, v42
    v_permlane16_swap_b32 v41, v43
    v_cvt_pk_bf16_f32 v44, v24, v25
    v_cvt_pk_bf16_f32 v45, v26, v27
    v_cvt_pk_bf16_f32 v46, v28, v29
    v_cvt_pk_bf16_f32 v47, v30, v31
    buffer_store_dwordx4 v[40:43], v10, s[44:47], s80 offen sc1
    buffer_store_dwordx4 v[44:47], v6, s[44:47], s80 offen offset:1024 sc1
    ds_write_b128 v126, v[40:43]
    ds_write_b128 v127, v[44:47] offset:1024
    s_setprio 2
    v_mov_b32 v124, 0x3f803f80
    v_mov_b32 v125, 0x3f803f80
    v_mov_b32 v126, 0x3f803f80
    v_mov_b32 v127, 0x3f803f80
    v_and_b32 v88, 7, v0
    v_mul_u32_u24 v90, 16512, v88
    v_add_u32 v90, s79, v90
    s_mov_b64 exec, 3
    ds_write_b128 v90, v[124:127] offset:2048
    s_mov_b64 exec, -1
    v_lshlrev_b32 v88, 2, v88
    v_add_u32 v88, 148480, v88
    v_mov_b32 v91, s62
    ds_read_b32 v88, v88
    s_waitcnt lgkmcnt(7)
    v_mfma_f32_16x16x32_bf16 v[32:35], v[56:59], v[128:131], 0
    v_mfma_f32_16x16x32_bf16 v[36:39], v[56:59], v[132:135], 0
    ds_read_b128 v[72:75], v9 offset:12288
    s_waitcnt lgkmcnt(7)
    v_mfma_f32_16x16x32_bf16 v[32:35], v[60:63], v[136:139], v[32:35]
    v_mfma_f32_16x16x32_bf16 v[36:39], v[60:63], v[140:143], v[36:39]
    ds_read_b128 v[76:79], v9 offset:15360
    s_waitcnt lgkmcnt(7)
    v_mfma_f32_16x16x32_bf16 v[32:35], v[64:67], v[144:147], v[32:35]
    v_mfma_f32_16x16x32_bf16 v[36:39], v[64:67], v[148:151], v[36:39]
    ds_read_b128 v[80:83], v9 offset:18432
    s_waitcnt lgkmcnt(7)
    v_mfma_f32_16x16x32_bf16 v[32:35], v[68:71], v[152:155], v[32:35]
    v_mfma_f32_16x16x32_bf16 v[36:39], v[68:71], v[156:159], v[36:39]
    ds_read_b128 v[84:87], v9 offset:21504
    s_waitcnt lgkmcnt(4)
    v_cmp_ne_u32 vcc, 0, v88
    v_mov_b32 v89, 149760
    v_mov_b32 v1, 1
    s_cmp_eq_u64 vcc, 0
    s_cselect_b32 s66, 1, 0
    s_waitcnt lgkmcnt(3)
    v_mfma_f32_16x16x32_bf16 v[32:35], v[72:75], v[160:163], v[32:35]
    v_mfma_f32_16x16x32_bf16 v[36:39], v[72:75], v[164:167], v[36:39]
    ds_read_b128 v[56:59], v9 offset:24576
    s_waitcnt lgkmcnt(3)
    v_mfma_f32_16x16x32_bf16 v[32:35], v[76:79], v[168:171], v[32:35]
    v_mfma_f32_16x16x32_bf16 v[36:39], v[76:79], v[172:175], v[36:39]
    ds_read_b128 v[60:63], v9 offset:27648
    s_waitcnt lgkmcnt(3)
    v_mfma_f32_16x16x32_bf16 v[32:35], v[80:83], v[176:179], v[32:35]
    v_mfma_f32_16x16x32_bf16 v[36:39], v[80:83], v[180:183], v[36:39]
    ds_read_b128 v[64:67], v9 offset:30720
    s_waitcnt lgkmcnt(3)
    v_mfma_f32_16x16x32_bf16 v[32:35], v[84:87], v[184:187], v[32:35]
    v_mfma_f32_16x16x32_bf16 v[36:39], v[84:87], v[188:191], v[36:39]
    ds_read_b128 v[68:71], v9 offset:33792
    s_barrier
    s_waitcnt lgkmcnt(3)
    v_mfma_f32_16x16x32_bf16 v[32:35], v[56:59], v[192:195], v[32:35]
    v_mfma_f32_16x16x32_bf16 v[36:39], v[56:59], v[196:199], v[36:39]
    ds_read_b128 v[72:75], v9 offset:36864
    s_waitcnt lgkmcnt(3)
    v_mfma_f32_16x16x32_bf16 v[32:35], v[60:63], v[200:203], v[32:35]
    v_mfma_f32_16x16x32_bf16 v[36:39], v[60:63], v[204:207], v[36:39]
    ds_read_b128 v[76:79], v9 offset:39936
    s_waitcnt lgkmcnt(3)
    v_mfma_f32_16x16x32_bf16 v[32:35], v[64:67], v[208:211], v[32:35]
    v_mfma_f32_16x16x32_bf16 v[36:39], v[64:67], v[212:215], v[36:39]
    ds_read_b128 v[80:83], v9 offset:43008
    s_waitcnt lgkmcnt(3)
    v_mfma_f32_16x16x32_bf16 v[32:35], v[68:71], v[216:219], v[32:35]
    v_mfma_f32_16x16x32_bf16 v[36:39], v[68:71], v[220:223], v[36:39]
    ds_read_b128 v[84:87], v9 offset:46080
    s_waitcnt lgkmcnt(3)
    v_mfma_f32_16x16x32_bf16 v[32:35], v[72:75], v[224:227], v[32:35]
    v_mfma_f32_16x16x32_bf16 v[36:39], v[72:75], v[228:231], v[36:39]
    s_waitcnt lgkmcnt(2)
    v_mfma_f32_16x16x32_bf16 v[32:35], v[76:79], v[232:235], v[32:35]
    v_mfma_f32_16x16x32_bf16 v[36:39], v[76:79], v[236:239], v[36:39]
    s_waitcnt vmcnt(0)
    s_mov_b64 exec, 1
    ds_add_rtn_u32 v88, v89, v1
    s_mov_b64 exec, -1
    s_waitcnt lgkmcnt(2)
    v_mfma_f32_16x16x32_bf16 v[32:35], v[80:83], v[240:243], v[32:35]
    v_mfma_f32_16x16x32_bf16 v[36:39], v[80:83], v[244:247], v[36:39]
    s_waitcnt lgkmcnt(1)
    v_mfma_f32_16x16x32_bf16 v[32:35], v[84:87], v[248:251], v[32:35]
    v_mfma_f32_16x16x32_bf16 v[36:39], v[84:87], v[252:255], v[36:39]
    s_waitcnt lgkmcnt(0)
    v_readfirstlane_b32 s76, v88
    s_nop 0
    s_cmp_lg_u32 s76, 7
    s_cbranch_scc1 L_skip_18
    s_mov_b64 exec, 1
    buffer_store_dword v91, v6, s[44:47], s81 offen sc1
    s_mov_b64 exec, -1
L_skip_18:
    s_nop 1
    v_fma_f32 v32, v121, v32, v48
    v_fma_f32 v33, v121, v33, v49
    v_fma_f32 v34, v121, v34, v50
    v_fma_f32 v35, v121, v35, v51
    v_fma_f32 v36, v123, v36, v52
    v_fma_f32 v37, v123, v37, v53
    v_fma_f32 v38, v123, v38, v54
    v_fma_f32 v39, v123, v39, v55
    v_cvt_pk_bf16_f32 v64, v32, v33
    v_cvt_pk_bf16_f32 v65, v34, v35
    v_cvt_pk_bf16_f32 v66, v36, v37
    v_cvt_pk_bf16_f32 v67, v38, v39
    s_nop 0
    v_permlane16_swap_b32 v64, v66
    v_permlane16_swap_b32 v65, v67
    s_lshl_b32 s38, s60, 14
    s_lshl_b32 s39, s3, 11
    s_add_u32 s39, s39, s68
    s_mov_b32 s41, s79
    s_add_u32 s38, s38, 0x4000
    s_and_b32 s38, s38, 0x1ffff
    ds_read_b128 v[68:71], v3 offset:0
    ds_read_b128 v[76:79], v4 offset:0
    ds_read_b128 v[80:83], v4 offset:2064
    v_mov_b32 v48, 0
    v_mov_b32 v49, 0
    v_mov_b32 v50, 0
    v_mov_b32 v51, 0
    v_mov_b32 v52, 0
    v_mov_b32 v53, 0
    v_mov_b32 v54, 0
    v_mov_b32 v55, 0
    v_mov_b32 v56, 0
    v_mov_b32 v57, 0
    v_mov_b32 v58, 0
    v_mov_b32 v59, 0
    v_mov_b32 v60, 0
    v_mov_b32 v61, 0
    v_mov_b32 v62, 0
    v_mov_b32 v63, 0
    s_setprio 0
    s_cmp_ge_u32 s3, 4
    s_cbranch_scc1 L_onlyA_19
    s_setprio 1
L_onlyA_19:
    s_waitcnt lgkmcnt(2)
    v_mfma_f32_32x32x16_bf16 v[16:31], v[68:71], v[64:67], 0
    ds_read_b128 v[68:71], v3 offset:2064
    s_cmp_ge_u32 s3, 4
    s_cbranch_scc1 L_onlyA_20
    v_min_u32 v85, 6, v0
    v_add3_u32 v85, v85, s60, 1
    v_and_b32 v85, 7, v85
    v_lshlrev_b32 v85, 7, v85
    s_lshl_b32 s80, s61, 10
    s_add_u32 s80, s80, 65536
    buffer_load_dword v84, v85, s[44:47], s80 offen sc1
L_onlyA_20:
    v_add_u32 v94, s26, v95
    ds_read_b64_tr_b16 v[112:113], v95
    ds_read_b64_tr_b16 v[114:115], v94
    v_add_u32 v95, s75, v95
    v_add_u32 v94, s75, v94
    ds_read_b64_tr_b16 v[116:117], v95
    ds_read_b64_tr_b16 v[118:119], v94
    s_nop 1
    v_exp_f32 v16, v16
    v_exp_f32 v17, v17
    ds_read_b128 v[72:75], v5 offset:0
    v_exp_f32 v18, v18
    v_exp_f32 v19, v19
    v_exp_f32 v20, v20
    s_waitcnt lgkmcnt(5)
    v_mfma_f32_32x32x16_bf16 v[32:47], v[68:71], v[64:67], 0
    ds_read_b128 v[68:71], v3 offset:4128
    v_exp_f32 v21, v21
    v_exp_f32 v22, v22
    v_exp_f32 v23, v23
    v_exp_f32 v24, v24
    v_exp_f32 v25, v25
    v_smfmac_f32_32x32x32_bf16 v[48:63], v[76:79], v[16:23], v2
    ds_read_b128 v[76:79], v4 offset:4128
    s_waitcnt lgkmcnt(5)
    buffer_store_dwordx4 v[112:115], v6, s[44:47], s72 offen sc1
    s_waitcnt lgkmcnt(3)
    buffer_store_dwordx4 v[116:119], v6, s[44:47], s40 offen sc1
    v_exp_f32 v26, v26
    v_exp_f32 v27, v27
    v_exp_f32 v28, v28
    v_exp_f32 v29, v29
    v_exp_f32 v30, v30
    v_exp_f32 v31, v31
    v_exp_f32 v32, v32
    s_waitcnt lgkmcnt(1)
    v_exp_f32 v33, v33
    v_smfmac_f32_32x32x32_bf16 v[48:63], v[72:75], v[24:31], v2
    ds_read_b128 v[72:75], v5 offset:2064
    v_exp_f32 v34, v34
    v_exp_f32 v35, v35
    v_exp_f32 v36, v36
    v_mfma_f32_32x32x16_bf16 v[16:31], v[68:71], v[64:67], 0
    ds_read_b128 v[68:71], v3 offset:6192
    v_exp_f32 v37, v37
    v_exp_f32 v38, v38
    v_exp_f32 v39, v39
    v_exp_f32 v40, v40
    v_exp_f32 v41, v41
    v_smfmac_f32_32x32x32_bf16 v[48:63], v[80:83], v[32:39], v2
    ds_read_b128 v[80:83], v4 offset:6192
    v_exp_f32 v42, v42
    v_exp_f32 v43, v43
    v_exp_f32 v44, v44
    v_exp_f32 v45, v45
    v_exp_f32 v46, v46
    v_exp_f32 v47, v47
    s_cmp_ge_u32 s3, 4
    s_cbranch_scc1 L_onlyA_21
    s_waitcnt vmcnt(2)
    v_cmp_ne_u32 vcc, s62, v84
    s_nop 0
    s_bitcmp0_b32 vcc_lo, 0
    s_cbranch_scc1 L_ok_22
    v_mov_b32 v84, s62
    s_mov_b32 s67, 0x40000
L_poll_23:
    s_mov_b64 exec, 1
    buffer_load_dword v84, v85, s[44:47], s80 offen sc1
    s_mov_b64 exec, -1
    s_sub_u32 s67, s67, 1
    s_cbranch_scc1 L_polld_24
    s_waitcnt vmcnt(0)
    v_cmp_ne_u32 vcc, s62, v84
    s_nop 0
    s_cbranch_vccnz L_poll_23
L_polld_24:
    s_waitcnt vmcnt(0)
L_ok_22:
    s_add_u32 m0, s41, 16512
    s_add_u32 s76, s38, s39
    buffer_load_dwordx4 v6, s[44:47], s76 offen sc1 lds
    buffer_load_dwordx4 v6, s[44:47], s76 offen offset:1024 sc1 lds
    s_add_u32 m0, s41, 24768
    s_add_u32 s76, s38, s39
    s_add_u32 s76, s76, 8192
    buffer_load_dwordx4 v6, s[44:47], s76 offen sc1 lds
    buffer_load_dwordx4 v6, s[44:47], s76 offen offset:1024 sc1 lds
    buffer_load_dword v84, v85, s[44:47], s80 offen sc1
    s_setprio 0
L_onlyA_21:
    v_exp_f32 v16, v16
    s_waitcnt lgkmcnt(1)
    v_exp_f32 v17, v17
    v_smfmac_f32_32x32x32_bf16 v[48:63], v[72:75], v[40:47], v2
    ds_read_b128 v[72:75], v5 offset:4128
    v_exp_f32 v18, v18
    v_exp_f32 v19, v19
    v_exp_f32 v20, v20
    v_mfma_f32_32x32x16_bf16 v[32:47], v[68:71], v[64:67], 0
    ds_read_b128 v[68:71], v3 offset:8256
    v_exp_f32 v21, v21
    v_exp_f32 v22, v22
    v_exp_f32 v23, v23
    v_exp_f32 v24, v24
    v_exp_f32 v25, v25
    v_smfmac_f32_32x32x32_bf16 v[48:63], v[76:79], v[16:23], v2
    ds_read_b128 v[76:79], v4 offset:8256
    v_exp_f32 v26, v26
    v_exp_f32 v27, v27
    v_exp_f32 v28, v28
    v_exp_f32 v29, v29
    v_exp_f32 v30, v30
    v_exp_f32 v31, v31
    v_exp_f32 v32, v32
    s_waitcnt lgkmcnt(1)
    v_exp_f32 v33, v33
    v_smfmac_f32_32x32x32_bf16 v[48:63], v[72:75], v[24:31], v2
    ds_read_b128 v[72:75], v5 offset:6192
    v_exp_f32 v34, v34
    v_exp_f32 v35, v35
    v_exp_f32 v36, v36
    v_mfma_f32_32x32x16_bf16 v[16:31], v[68:71], v[64:67], 0
    ds_read_b128 v[68:71], v3 offset:10320
    v_exp_f32 v37, v37
    v_exp_f32 v38, v38
    v_exp_f32 v39, v39
    v_exp_f32 v40, v40
    v_exp_f32 v41, v41
    v_smfmac_f32_32x32x32_bf16 v[48:63], v[80:83], v[32:39], v2
    ds_read_b128 v[80:83], v4 offset:10320
    v_exp_f32 v42, v42
    v_exp_f32 v43, v43
    v_exp_f32 v44, v44
    v_exp_f32 v45, v45
    v_exp_f32 v46, v46
    v_exp_f32 v47, v47
    v_exp_f32 v16, v16
    s_waitcnt lgkmcnt(1)
    v_exp_f32 v17, v17
    v_smfmac_f32_32x32x32_bf16 v[48:63], v[72:75], v[40:47], v2
    ds_read_b128 v[72:75], v5 offset:8256
    v_exp_f32 v18, v18
    v_exp_f32 v19, v19
    v_exp_f32 v20, v20
    v_mfma_f32_32x32x16_bf16 v[32:47], v[68:71], v[64:67], 0
    ds_read_b128 v[68:71], v3 offset:12384
    v_exp_f32 v21, v21
    v_exp_f32 v22, v22
    v_exp_f32 v23, v23
    v_exp_f32 v24, v24
    v_exp_f32 v25, v25
    v_smfmac_f32_32x32x32_bf16 v[48:63], v[76:79], v[16:23], v2
    ds_read_b128 v[76:79], v4 offset:12384
    v_exp_f32 v26, v26
    v_exp_f32 v27, v27
    v_exp_f32 v28, v28
    v_exp_f32 v29, v29
    v_exp_f32 v30, v30
    v_exp_f32 v31, v31
    v_exp_f32 v32, v32
    s_waitcnt lgkmcnt(1)
    v_exp_f32 v33, v33
    v_smfmac_f32_32x32x32_bf16 v[48:63], v[72:75], v[24:31], v2
    ds_read_b128 v[72:75], v5 offset:10320
    v_exp_f32 v34, v34
    v_exp_f32 v35, v35
    v_exp_f32 v36, v36
    v_mfma_f32_32x32x16_bf16 v[16:31], v[68:71], v[64:67], 0
    ds_read_b128 v[68:71], v3 offset:14448
    v_exp_f32 v37, v37
    v_exp_f32 v38, v38
    v_exp_f32 v39, v39
    v_exp_f32 v40, v40
    v_exp_f32 v41, v41
    v_smfmac_f32_32x32x32_bf16 v[48:63], v[80:83], v[32:39], v2
    ds_read_b128 v[80:83], v4 offset:14448
    v_exp_f32 v42, v42
    v_exp_f32 v43, v43
    v_exp_f32 v44, v44
    v_exp_f32 v45, v45
    v_exp_f32 v46, v46
    v_exp_f32 v47, v47
    s_cmp_ge_u32 s3, 4
    s_cbranch_scc1 L_onlyA_25
    s_waitcnt vmcnt(0)
    v_cmp_ne_u32 vcc, s62, v84
    s_nop 0
    s_cbranch_vccnz L_again_27
L_ok_26:
L_onlyA_25:
    s_cmp_lt_u32 s3, 4
    s_cbranch_scc1 L_skip_30
    s_waitcnt vmcnt(0)
L_skip_30:
    s_waitcnt vmcnt(1)
    s_barrier
    s_setprio 3
    s_cmp_lg_u32 s3, 0
    s_cbranch_scc0 L_rare_31
L_back_32:
    v_exp_f32 v16, v16
    s_waitcnt lgkmcnt(1)
    v_exp_f32 v17, v17
    v_smfmac_f32_32x32x32_bf16 v[48:63], v[72:75], v[40:47], v2
    ds_read_b128 v[72:75], v5 offset:12384
    v_exp_f32 v18, v18
    v_exp_f32 v19, v19
    v_exp_f32 v20, v20
    v_mfma_f32_32x32x16_bf16 v[32:47], v[68:71], v[64:67], 0
    ds_read_b128 v[68:71], v3 offset:16512
    v_exp_f32 v21, v21
    v_exp_f32 v22, v22
    v_exp_f32 v23, v23
    v_exp_f32 v24, v24
    v_exp_f32 v25, v25
    v_smfmac_f32_32x32x32_bf16 v[48:63], v[76:79], v[16:23], v2
    ds_read_b128 v[76:79], v4 offset:16512
    s_add_u32 s38, s38, 0x4000
    s_and_b32 s38, s38, 0x1ffff
    s_add_u32 m0, s41, 33024
    s_add_u32 s76, s38, s39
    buffer_load_dwordx4 v6, s[44:47], s76 offen sc1 lds
    buffer_load_dwordx4 v6, s[44:47], s76 offen offset:1024 sc1 lds
    v_exp_f32 v26, v26
    v_exp_f32 v27, v27
    v_exp_f32 v28, v28
    v_exp_f32 v29, v29
    v_exp_f32 v30, v30
    v_exp_f32 v31, v31
    s_mov_b64 exec, 60
    ds_write_b128 v90, v[124:127] offset:2048
    s_mov_b64 exec, -1
    v_exp_f32 v32, v32
    s_waitcnt lgkmcnt(2)
    v_exp_f32 v33, v33
    v_smfmac_f32_32x32x32_bf16 v[48:63], v[72:75], v[24:31], v2
    ds_read_b128 v[72:75], v5 offset:14448
    v_exp_f32 v34, v34
    v_exp_f32 v35, v35
    v_exp_f32 v36, v36
    v_mfma_f32_32x32x16_bf16 v[16:31], v[68:71], v[64:67], 0
    ds_read_b128 v[68:71], v3 offset:18576
    v_exp_f32 v37, v37
    v_exp_f32 v38, v38
    v_exp_f32 v39, v39
    v_exp_f32 v40, v40
    v_exp_f32 v41, v41
    v_smfmac_f32_32x32x32_bf16 v[48:63], v[80:83], v[32:39], v2
    ds_read_b128 v[80:83], v4 offset:18576
    v_exp_f32 v42, v42
    v_exp_f32 v43, v43
    v_exp_f32 v44, v44
    v_exp_f32 v45, v45
    v_exp_f32 v46, v46
    v_exp_f32 v47, v47
    s_cmp_lt_u32 s61, 24
    s_cbranch_scc0 L_rare_33
L_back_34:
    v_exp_f32 v16, v16
    s_waitcnt lgkmcnt(1)
    v_exp_f32 v17, v17
    v_smfmac_f32_32x32x32_bf16 v[48:63], v[72:75], v[40:47], v2
    ds_read_b128 v[72:75], v5 offset:16512
    v_exp_f32 v18, v18
    v_exp_f32 v19, v19
    v_exp_f32 v20, v20
    v_mfma_f32_32x32x16_bf16 v[32:47], v[68:71], v[64:67], 0
    ds_read_b128 v[68:71], v3 offset:20640
    v_exp_f32 v21, v21
    v_exp_f32 v22, v22
    v_exp_f32 v23, v23
    v_exp_f32 v24, v24
    v_exp_f32 v25, v25
    v_smfmac_f32_32x32x32_bf16 v[48:63], v[76:79], v[16:23], v2
    ds_read_b128 v[76:79], v4 offset:20640
    v_exp_f32 v26, v26
    v_exp_f32 v27, v27
    v_exp_f32 v28, v28
    v_exp_f32 v29, v29
    v_exp_f32 v30, v30
    v_exp_f32 v31, v31
    v_exp_f32 v32, v32
    s_waitcnt lgkmcnt(1)
    v_exp_f32 v33, v33
    v_smfmac_f32_32x32x32_bf16 v[48:63], v[72:75], v[24:31], v2
    ds_read_b128 v[72:75], v5 offset:18576
    v_exp_f32 v34, v34
    v_exp_f32 v35, v35
    v_exp_f32 v36, v36
    v_mfma_f32_32x32x16_bf16 v[16:31], v[68:71], v[64:67], 0
    ds_read_b128 v[68:71], v3 offset:22704
    v_exp_f32 v37, v37
    v_exp_f32 v38, v38
    v_exp_f32 v39, v39
    v_exp_f32 v40, v40
    v_exp_f32 v41, v41
    v_smfmac_f32_32x32x32_bf16 v[48:63], v[80:83], v[32:39], v2
    ds_read_b128 v[80:83], v4 offset:22704
    v_exp_f32 v42, v42
    v_exp_f32 v43, v43
    v_exp_f32 v44, v44
    v_exp_f32 v45, v45
    v_exp_f32 v46, v46
    v_exp_f32 v47, v47
    s_setprio 2
    v_exp_f32 v16, v16
    s_waitcnt lgkmcnt(1)
    v_exp_f32 v17, v17
    v_smfmac_f32_32x32x32_bf16 v[48:63], v[72:75], v[40:47], v2
    ds_read_b128 v[72:75], v5 offset:20640
    v_exp_f32 v18, v18
    v_exp_f32 v19, v19
    v_exp_f32 v20, v20
    v_mfma_f32_32x32x16_bf16 v[32:47], v[68:71], v[64:67], 0
    ds_read_b128 v[68:71], v3 offset:24768
    v_exp_f32 v21, v21
    v_exp_f32 v22, v22
    v_exp_f32 v23, v23
    v_exp_f32 v24, v24
    v_exp_f32 v25, v25
    v_smfmac_f32_32x32x32_bf16 v[48:63], v[76:79], v[16:23], v2
    ds_read_b128 v[76:79], v4 offset:24768
    s_add_u32 s38, s38, 0x4000
    s_and_b32 s38, s38, 0x1ffff
    s_add_u32 m0, s41, 49536
    s_add_u32 s76, s38, s39
    buffer_load_dwordx4 v6, s[44:47], s76 offen sc1 lds
    buffer_load_dwordx4 v6, s[44:47], s76 offen offset:1024 sc1 lds
    v_exp_f32 v26, v26
    v_exp_f32 v27, v27
    v_exp_f32 v28, v28
    v_exp_f32 v29, v29
    v_exp_f32 v30, v30
    v_exp_f32 v31, v31
    v_exp_f32 v32, v32
    s_waitcnt lgkmcnt(1)
    v_exp_f32 v33, v33
    v_smfmac_f32_32x32x32_bf16 v[48:63], v[72:75], v[24:31], v2
    ds_read_b128 v[72:75], v5 offset:22704
    v_exp_f32 v34, v34
    v_exp_f32 v35, v35
    v_exp_f32 v36, v36
    v_mfma_f32_32x32x16_bf16 v[16:31], v[68:71], v[64:67], 0
    ds_read_b128 v[68:71], v3 offset:26832
    v_exp_f32 v37, v37
    v_exp_f32 v38, v38
    v_exp_f32 v39, v39
    v_exp_f32 v40, v40
    v_exp_f32 v41, v41
    v_smfmac_f32_32x32x32_bf16 v[48:63], v[80:83], v[32:39], v2
    ds_read_b128 v[80:83], v4 offset:26832
    v_exp_f32 v42, v42
    v_exp_f32 v43, v43
    v_exp_f32 v44, v44
    v_exp_f32 v45, v45
    v_exp_f32 v46, v46
    v_exp_f32 v47, v47
    s_setprio 1
    v_exp_f32 v16, v16
    s_waitcnt lgkmcnt(1)
    v_exp_f32 v17, v17
    v_smfmac_f32_32x32x32_bf16 v[48:63], v[72:75], v[40:47], v2
    ds_read_b128 v[72:75], v5 offset:24768
    v_exp_f32 v18, v18
    v_exp_f32 v19, v19
    v_exp_f32 v20, v20
    v_mfma_f32_32x32x16_bf16 v[32:47], v[68:71], v[64:67], 0
    ds_read_b128 v[68:71], v3 offset:28896
    v_exp_f32 v21, v21
    v_exp_f32 v22, v22
    v_exp_f32 v23, v23
    v_exp_f32 v24, v24
    v_exp_f32 v25, v25
    v_smfmac_f32_32x32x32_bf16 v[48:63], v[76:79], v[16:23], v2
    ds_read_b128 v[76:79], v4 offset:28896
    v_exp_f32 v26, v26
    v_exp_f32 v27, v27
    v_exp_f32 v28, v28
    v_exp_f32 v29, v29
    v_exp_f32 v30, v30
    v_exp_f32 v31, v31
    s_setprio 0
    s_cmp_lt_u32 s61, 24
    s_cbranch_scc0 L_rare_35
L_back_36:
    v_exp_f32 v32, v32
    s_waitcnt lgkmcnt(1)
    v_exp_f32 v33, v33
    v_smfmac_f32_32x32x32_bf16 v[48:63], v[72:75], v[24:31], v2
    ds_read_b128 v[72:75], v5 offset:26832
    v_exp_f32 v34, v34
    v_exp_f32 v35, v35
    v_exp_f32 v36, v36
    v_mfma_f32_32x32x16_bf16 v[16:31], v[68:71], v[64:67], 0
    ds_read_b128 v[68:71], v3 offset:30960
    v_exp_f32 v37, v37
    v_exp_f32 v38, v38
    v_exp_f32 v39, v39
    v_exp_f32 v40, v40
    v_exp_f32 v41, v41
    v_smfmac_f32_32x32x32_bf16 v[48:63], v[80:83], v[32:39], v2
    ds_read_b128 v[80:83], v4 offset:30960
    v_exp_f32 v42, v42
    v_exp_f32 v43, v43
    v_exp_f32 v44, v44
    v_exp_f32 v45, v45
    v_exp_f32 v46, v46
    v_exp_f32 v47, v47
    s_waitcnt vmcnt(2)
    s_barrier
    s_setprio 3
    v_exp_f32 v16, v16
    s_waitcnt lgkmcnt(1)
    v_exp_f32 v17, v17
    v_smfmac_f32_32x32x32_bf16 v[48:63], v[72:75], v[40:47], v2
    ds_read_b128 v[72:75], v5 offset:28896
    v_exp_f32 v18, v18
    v_exp_f32 v19, v19
    v_exp_f32 v20, v20
    v_mfma_f32_32x32x16_bf16 v[32:47], v[68:71], v[64:67], 0
    ds_read_b128 v[68:71], v3 offset:33024
    v_exp_f32 v21, v21
    v_exp_f32 v22, v22
    v_exp_f32 v23, v23
    v_exp_f32 v24, v24
    v_exp_f32 v25, v25
    v_smfmac_f32_32x32x32_bf16 v[48:63], v[76:79], v[16:23], v2
    ds_read_b128 v[76:79], v4 offset:33024
    s_add_u32 s38, s38, 0x4000
    s_and_b32 s38, s38, 0x1ffff
    s_add_u32 m0, s41, 66048
    s_add_u32 s76, s38, s39
    buffer_load_dwordx4 v6, s[44:47], s76 offen sc1 lds
    buffer_load_dwordx4 v6, s[44:47], s76 offen offset:1024 sc1 lds
    v_exp_f32 v26, v26
    v_exp_f32 v27, v27
    v_exp_f32 v28, v28
    v_exp_f32 v29, v29
    v_exp_f32 v30, v30
    v_exp_f32 v31, v31
    s_cmp_lt_u32 s61, 24
    s_cbranch_scc0 L_rare_37
L_back_38:
    v_exp_f32 v32, v32
    s_waitcnt lgkmcnt(1)
    v_exp_f32 v33, v33
    v_smfmac_f32_32x32x32_bf16 v[48:63], v[72:75], v[24:31], v2
    ds_read_b128 v[72:75], v5 offset:30960
    v_exp_f32 v34, v34
    v_exp_f32 v35, v35
    v_exp_f32 v36, v36
    v_mfma_f32_32x32x16_bf16 v[16:31], v[68:71], v[64:67], 0
    ds_read_b128 v[68:71], v3 offset:35088
    v_exp_f32 v37, v37
    v_exp_f32 v38, v38
    v_exp_f32 v39, v39
    v_exp_f32 v40, v40
    v_exp_f32 v41, v41
    v_smfmac_f32_32x32x32_bf16 v[48:63], v[80:83], v[32:39], v2
    ds_read_b128 v[80:83], v4 offset:35088
    v_exp_f32 v42, v42
    v_exp_f32 v43, v43
    v_exp_f32 v44, v44
    v_exp_f32 v45, v45
    v_exp_f32 v46, v46
    v_exp_f32 v47, v47
    s_cmp_lt_u32 s61, 24
    s_cbranch_scc0 L_rare_39
L_back_40:
    s_lshl_b32 s81, s3, 12
    s_add_u32 s81, s81, 65540
    v_and_b32 v85, 31, v0
    v_lshlrev_b32 v85, 7, v85
    buffer_load_dword v84, v85, s[44:47], s81 offen sc1
    v_exp_f32 v16, v16
    s_waitcnt lgkmcnt(1)
    v_exp_f32 v17, v17
    v_smfmac_f32_32x32x32_bf16 v[48:63], v[72:75], v[40:47], v2
    ds_read_b128 v[72:75], v5 offset:33024
    v_exp_f32 v18, v18
    v_exp_f32 v19, v19
    v_exp_f32 v20, v20
    v_mfma_f32_32x32x16_bf16 v[32:47], v[68:71], v[64:67], 0
    ds_read_b128 v[68:71], v3 offset:37152
    v_exp_f32 v21, v21
    v_exp_f32 v22, v22
    v_exp_f32 v23, v23
    v_exp_f32 v24, v24
    v_exp_f32 v25, v25
    v_smfmac_f32_32x32x32_bf16 v[48:63], v[76:79], v[16:23], v2
    ds_read_b128 v[76:79], v4 offset:37152
    v_exp_f32 v26, v26
    v_exp_f32 v27, v27
    v_exp_f32 v28, v28
    v_exp_f32 v29, v29
    v_exp_f32 v30, v30
    v_exp_f32 v31, v31
    s_cmp_lt_u32 s61, 24
    s_cbranch_scc0 L_rare_41
L_back_42:
    v_exp_f32 v32, v32
    s_waitcnt lgkmcnt(1)
    v_exp_f32 v33, v33
    v_smfmac_f32_32x32x32_bf16 v[48:63], v[72:75], v[24:31], v2
    ds_read_b128 v[72:75], v5 offset:35088
    v_exp_f32 v34, v34
    v_exp_f32 v35, v35
    v_exp_f32 v36, v36
    v_mfma_f32_32x32x16_bf16 v[16:31], v[68:71], v[64:67], 0
    ds_read_b128 v[68:71], v3 offset:39216
    v_exp_f32 v37, v37
    v_exp_f32 v38, v38
    v_exp_f32 v39, v39
    v_exp_f32 v40, v40
    v_exp_f32 v41, v41
    v_smfmac_f32_32x32x32_bf16 v[48:63], v[80:83], v[32:39], v2
    ds_read_b128 v[80:83], v4 offset:39216
    v_exp_f32 v42, v42
    v_exp_f32 v43, v43
    v_exp_f32 v44, v44
    v_exp_f32 v45, v45
    v_exp_f32 v46, v46
    v_exp_f32 v47, v47
    s_setprio 2
    s_mul_i32 s76, s64, 11
    s_cmp_eq_u32 s64, 7
    s_cselect_b32 s76, 76, s76
    s_lshl_b32 s77, s3, 1
    s_add_u32 s73, s76, s77
    s_add_u32 s74, s73, 1
    s_add_u32 s77, s76, s3
    s_add_u32 s77, s77, 4
    s_min_u32 s77, s77, 85
    s_lshl_b32 s78, s64, 2
    s_add_u32 s78, s78, s3
    s_sub_u32 s78, s78, 4
    s_lshl_b32 s78, s78, 14
    s_add_u32 s78, s78, 131072
    s_lshl_b32 s69, s73, 14
    s_add_u32 s69, s69, 655360
    s_cmp_ge_u32 s3, 4
    s_cselect_b32 s69, s78, s69
    s_cselect_b32 s74, s77, s74
    s_cselect_b32 s73, s77, s73
    s_lshl_b32 s70, s74, 14
    s_add_u32 s70, s70, 655360
    s_and_b32 s76, s3, 3
    s_lshl2_add_u32 s76, s64, s76
    s_mul_i32 s75, s76, 44032
    s_lshr_b32 s26, s3, 2
    s_mul_i32 s76, s26, 22528
    s_add_u32 s75, s75, s76
    s_add_u32 s75, s75, 2097152
    v_exp_f32 v16, v16
    s_waitcnt lgkmcnt(1)
    v_exp_f32 v17, v17
    v_smfmac_f32_32x32x32_bf16 v[48:63], v[72:75], v[40:47], v2
    ds_read_b128 v[72:75], v5 offset:37152
    v_exp_f32 v18, v18
    v_exp_f32 v19, v19
    v_exp_f32 v20, v20
    v_mfma_f32_32x32x16_bf16 v[32:47], v[68:71], v[64:67], 0
    ds_read_b128 v[68:71], v3 offset:41280
    v_exp_f32 v21, v21
    v_exp_f32 v22, v22
    v_exp_f32 v23, v23
    v_exp_f32 v24, v24
    v_exp_f32 v25, v25
    v_smfmac_f32_32x32x32_bf16 v[48:63], v[76:79], v[16:23], v2
    ds_read_b128 v[76:79], v4 offset:41280
    s_add_u32 s38, s38, 0x4000
    s_and_b32 s38, s38, 0x1ffff
    s_add_u32 m0, s41, 82560
    s_add_u32 s76, s38, s39
    buffer_load_dwordx4 v6, s[44:47], s76 offen sc1 lds
    buffer_load_dwordx4 v6, s[44:47], s76 offen offset:1024 sc1 lds
    v_exp_f32 v26, v26
    v_exp_f32 v27, v27
    v_exp_f32 v28, v28
    v_exp_f32 v29, v29
    v_exp_f32 v30, v30
    v_exp_f32 v31, v31
    v_exp_f32 v32, v32
    s_waitcnt lgkmcnt(1)
    v_exp_f32 v33, v33
    v_smfmac_f32_32x32x32_bf16 v[48:63], v[72:75], v[24:31], v2
    ds_read_b128 v[72:75], v5 offset:39216
    v_exp_f32 v34, v34
    v_exp_f32 v35, v35
    v_exp_f32 v36, v36
    v_mfma_f32_32x32x16_bf16 v[16:31], v[68:71], v[64:67], 0
    ds_read_b128 v[68:71], v3 offset:43344
    v_exp_f32 v37, v37
    v_exp_f32 v38, v38
    v_exp_f32 v39, v39
    v_exp_f32 v40, v40
    v_exp_f32 v41, v41
    v_smfmac_f32_32x32x32_bf16 v[48:63], v[80:83], v[32:39], v2
    ds_read_b128 v[80:83], v4 offset:43344
    v_exp_f32 v42, v42
    v_exp_f32 v43, v43
    v_exp_f32 v44, v44
    v_exp_f32 v45, v45
    v_exp_f32 v46, v46
    v_exp_f32 v47, v47
    s_setprio 1
    v_exp_f32 v16, v16
    s_waitcnt lgkmcnt(1)
    v_exp_f32 v17, v17
    v_smfmac_f32_32x32x32_bf16 v[48:63], v[72:75], v[40:47], v2
    ds_read_b128 v[72:75], v5 offset:41280
    v_exp_f32 v18, v18
    v_exp_f32 v19, v19
    v_exp_f32 v20, v20
    v_mfma_f32_32x32x16_bf16 v[32:47], v[68:71], v[64:67], 0
    ds_read_b128 v[68:71], v3 offset:45408
    v_exp_f32 v21, v21
    v_exp_f32 v22, v22
    v_exp_f32 v23, v23
    v_exp_f32 v24, v24
    v_exp_f32 v25, v25
    v_smfmac_f32_32x32x32_bf16 v[48:63], v[76:79], v[16:23], v2
    ds_read_b128 v[76:79], v4 offset:45408
    v_exp_f32 v26, v26
    v_exp_f32 v27, v27
    v_exp_f32 v28, v28
    v_exp_f32 v29, v29
    v_exp_f32 v30, v30
    v_exp_f32 v31, v31
    s_setprio 0
    s_waitcnt vmcnt(2)
    v_cmp_ne_u32 vcc, s62, v84
    s_nop 0
    s_cbranch_vccnz L_again_44
L_ok_43:
    v_exp_f32 v32, v32
    s_waitcnt lgkmcnt(1)
    v_exp_f32 v33, v33
    v_smfmac_f32_32x32x32_bf16 v[48:63], v[72:75], v[24:31], v2
    ds_read_b128 v[72:75], v5 offset:43344
    v_exp_f32 v34, v34
    v_exp_f32 v35, v35
    v_exp_f32 v36, v36
    v_mfma_f32_32x32x16_bf16 v[16:31], v[68:71], v[64:67], 0
    ds_read_b128 v[68:71], v3 offset:47472
    v_exp_f32 v37, v37
    v_exp_f32 v38, v38
    v_exp_f32 v39, v39
    v_exp_f32 v40, v40
    v_exp_f32 v41, v41
    v_smfmac_f32_32x32x32_bf16 v[48:63], v[80:83], v[32:39], v2
    ds_read_b128 v[80:83], v4 offset:47472
    v_exp_f32 v42, v42
    v_exp_f32 v43, v43
    v_exp_f32 v44, v44
    v_exp_f32 v45, v45
    v_exp_f32 v46, v46
    v_exp_f32 v47, v47
    s_barrier
    s_setprio 3
    v_exp_f32 v16, v16
    s_waitcnt lgkmcnt(1)
    v_exp_f32 v17, v17
    v_smfmac_f32_32x32x32_bf16 v[48:63], v[72:75], v[40:47], v2
    ds_read_b128 v[72:75], v5 offset:45408
    v_exp_f32 v18, v18
    v_exp_f32 v19, v19
    v_exp_f32 v20, v20
    v_mfma_f32_32x32x16_bf16 v[32:47], v[68:71], v[64:67], 0
    ds_read_b128 v[68:71], v3 offset:49536
    v_exp_f32 v21, v21
    v_exp_f32 v22, v22
    v_exp_f32 v23, v23
    v_exp_f32 v24, v24
    v_exp_f32 v25, v25
    v_smfmac_f32_32x32x32_bf16 v[48:63], v[76:79], v[16:23], v2
    ds_read_b128 v[76:79], v4 offset:49536
    buffer_load_dwordx4 v[128:131], v6, s[44:47], s69 offen sc1
    v_exp_f32 v26, v26
    v_exp_f32 v27, v27
    v_exp_f32 v28, v28
    v_exp_f32 v29, v29
    v_exp_f32 v30, v30
    v_exp_f32 v31, v31
    s_mov_b64 exec, 192
    ds_write_b128 v90, v[124:127] offset:2048
    s_mov_b64 exec, -1
    v_exp_f32 v32, v32
    s_waitcnt lgkmcnt(2)
    v_exp_f32 v33, v33
    v_smfmac_f32_32x32x32_bf16 v[48:63], v[72:75], v[24:31], v2
    ds_read_b128 v[72:75], v5 offset:47472
    v_exp_f32 v34, v34
    v_exp_f32 v35, v35
    v_exp_f32 v36, v36
    v_mfma_f32_32x32x16_bf16 v[16:31], v[68:71], v[64:67], 0
    ds_read_b128 v[68:71], v3 offset:51600
    v_exp_f32 v37, v37
    v_exp_f32 v38, v38
    v_exp_f32 v39, v39
    v_exp_f32 v40, v40
    v_exp_f32 v41, v41
    v_smfmac_f32_32x32x32_bf16 v[48:63], v[80:83], v[32:39], v2
    ds_read_b128 v[80:83], v4 offset:51600
    s_add_u32 s38, s38, 0x4000
    s_and_b32 s38, s38, 0x1ffff
    s_add_u32 m0, s41, 99072
    s_add_u32 s76, s38, s39
    buffer_load_dwordx4 v6, s[44:47], s76 offen sc1 lds
    buffer_load_dwordx4 v6, s[44:47], s76 offen offset:1024 sc1 lds
    buffer_load_dwordx4 v[132:135], v6, s[44:47], s69 offen offset:1024 sc1
    v_exp_f32 v42, v42
    v_exp_f32 v43, v43
    v_exp_f32 v44, v44
    v_exp_f32 v45, v45
    v_exp_f32 v46, v46
    v_exp_f32 v47, v47
    v_exp_f32 v16, v16
    s_waitcnt lgkmcnt(1)
    v_exp_f32 v17, v17
    v_smfmac_f32_32x32x32_bf16 v[48:63], v[72:75], v[40:47], v2
    ds_read_b128 v[72:75], v5 offset:49536
    v_exp_f32 v18, v18
    v_exp_f32 v19, v19
    v_exp_f32 v20, v20
    v_mfma_f32_32x32x16_bf16 v[32:47], v[68:71], v[64:67], 0
    ds_read_b128 v[68:71], v3 offset:53664
    v_exp_f32 v21, v21
    v_exp_f32 v22, v22
    v_exp_f32 v23, v23
    v_exp_f32 v24, v24
    v_exp_f32 v25, v25
    v_smfmac_f32_32x32x32_bf16 v[48:63], v[76:79], v[16:23], v2
    ds_read_b128 v[76:79], v4 offset:53664
    buffer_load_dwordx4 v[136:139], v6, s[44:47], s69 offen offset:2048 sc1
    v_exp_f32 v26, v26
    v_exp_f32 v27, v27
    v_exp_f32 v28, v28
    v_exp_f32 v29, v29
    v_exp_f32 v30, v30
    v_exp_f32 v31, v31
    s_lshl_b32 s76, s3, 5
    s_add_u32 s76, s76, s61
    s_lshl_b32 s76, s76, 10
    s_add_u32 s4, s76, s65
    s_lshr_b32 s76, s3, 1
    s_lshl_b32 s76, s76, 5
    s_add_u32 s76, s76, s61
    s_and_b32 s77, s3, 1
    s_lshl1_add_u32 s76, s76, s77
    s_lshl2_add_u32 s76, s76, s65
    s_add_u32 s5, s76, 1294336
    s_lshl3_add_u32 s76, s63, s3
    s_lshl_b32 s77, s76, 5
    s_add_u32 s77, s77, s65
    s_andn2_b32 s18, s77, 0x7f
    s_add_u32 s18, s18, 1296384
    s_lshl_b32 s6, s3, 5
    s_add_u32 s6, s6, s77
    s_add_u32 s6, s6, 1294336
    s_add_u32 s77, s76, s3
    s_lshl_b32 s77, s77, 11
    s_add_u32 s77, s77, s65
    s_add_u32 s14, s77, 1212416
    s_and_b32 s77, s3, 3
    s_lshl_b32 s8, s77, 13
    s_lshl_b32 s76, s63, 16
    s_add_u32 s76, s76, s65
    s_add_u32 s7, s76, s8
    s_lshl2_add_u32 s77, s64, s77
    s_lshl_b32 s9, s77, 10
    s_add_u32 s9, s9, s76
    s_add_u32 s9, s9, 262144
    s_add_u32 s10, s9, 32768
    s_lshl_b32 s76, s63, 5
    s_add_u32 s76, s76, s77
    s_lshl_b32 s76, s76, 9
    s_add_u32 s76, s76, s65
    s_add_u32 s11, s76, 1228800
    s_lshl_b32 s76, s63, 8
    s_add_u32 s76, s76, s65
    s_add_u32 s76, s76, 1295360
    s_lshl2_add_u32 s12, s77, s76
    s_lshl_b32 s77, s3, 5
    s_add_u32 s13, s77, s76
    v_exp_f32 v32, v32
    s_waitcnt lgkmcnt(1)
    v_exp_f32 v33, v33
    v_smfmac_f32_32x32x32_bf16 v[48:63], v[72:75], v[24:31], v2
    ds_read_b128 v[72:75], v5 offset:51600
    v_exp_f32 v34, v34
    v_exp_f32 v35, v35
    v_exp_f32 v36, v36
    v_mfma_f32_32x32x16_bf16 v[16:31], v[68:71], v[64:67], 0
    ds_read_b128 v[68:71], v3 offset:55728
    v_exp_f32 v37, v37
    v_exp_f32 v38, v38
    v_exp_f32 v39, v39
    v_exp_f32 v40, v40
    v_exp_f32 v41, v41
    v_smfmac_f32_32x32x32_bf16 v[48:63], v[80:83], v[32:39], v2
    ds_read_b128 v[80:83], v4 offset:55728
    buffer_load_dwordx4 v[140:143], v6, s[44:47], s69 offen offset:3072 sc1
    s_add_u32 s69, s69, 4096
    v_exp_f32 v42, v42
    v_exp_f32 v43, v43
    v_exp_f32 v44, v44
    v_exp_f32 v45, v45
    v_exp_f32 v46, v46
    v_exp_f32 v47, v47
    v_exp_f32 v16, v16
    s_waitcnt lgkmcnt(1)
    v_exp_f32 v17, v17
    v_smfmac_f32_32x32x32_bf16 v[48:63], v[72:75], v[40:47], v2
    ds_read_b128 v[72:75], v5 offset:53664
    v_exp_f32 v18, v18
    v_exp_f32 v19, v19
    v_exp_f32 v20, v20
    v_mfma_f32_32x32x16_bf16 v[32:47], v[68:71], v[64:67], 0
    ds_read_b128 v[68:71], v3 offset:57792
    v_exp_f32 v21, v21
    v_exp_f32 v22, v22
    v_exp_f32 v23, v23
    v_exp_f32 v24, v24
    v_exp_f32 v25, v25
    v_smfmac_f32_32x32x32_bf16 v[48:63], v[76:79], v[16:23], v2
    ds_read_b128 v[76:79], v4 offset:57792
    buffer_load_dwordx4 v[144:147], v6, s[44:47], s69 offen sc1
    v_exp_f32 v26, v26
    v_exp_f32 v27, v27
    v_exp_f32 v28, v28
    v_exp_f32 v29, v29
    v_exp_f32 v30, v30
    v_exp_f32 v31, v31
    s_mul_i32 s76, s63, 176128
    s_add_u32 s76, s76, s65
    s_add_u32 s76, s76, 524288
    s_lshl_b32 s77, s73, 10
    s_add_u32 s15, s76, s77
    s_add_u32 s16, s15, 88064
    s_mul_i32 s77, s26, 45056
    s_add_u32 s19, s76, s77
    s_bitcmp1_b32 s3, 1
    s_cselect_b32 s77, 88064, 0
    s_add_u32 s19, s19, s77
    s_and_b32 s77, s3, 1
    s_lshl_b32 s77, s77, 12
    s_add_u32 s19, s19, s77
    s_lshl3_add_u32 s76, s61, s3
    s_lshl2_add_u32 s76, s76, s65
    s_add_u32 s17, s76, 1296384
    s_lshl2_add_u32 s76, s60, s63
    s_lshl_b32 s76, s76, 16
    s_lshl_b32 s77, s64, 7
    s_add_u32 s76, s76, s77
    s_lshl_b32 s77, s3, 12
    s_add_u32 s32, s76, s77
    s_lshl_b32 s36, s77, 2
    s_cmp_lt_u32 s64, 6
    s_cselect_b32 s33, 7, 6
    s_lshl_b32 s34, s3, 5
    s_add_u32 s34, s34, 131968
    v_exp_f32 v32, v32
    s_waitcnt lgkmcnt(1)
    v_exp_f32 v33, v33
    v_smfmac_f32_32x32x32_bf16 v[48:63], v[72:75], v[24:31], v2
    ds_read_b128 v[72:75], v5 offset:55728
    v_exp_f32 v34, v34
    v_exp_f32 v35, v35
    v_exp_f32 v36, v36
    v_mfma_f32_32x32x16_bf16 v[16:31], v[68:71], v[64:67], 0
    ds_read_b128 v[68:71], v3 offset:59856
    v_exp_f32 v37, v37
    v_exp_f32 v38, v38
    v_exp_f32 v39, v39
    v_exp_f32 v40, v40
    v_exp_f32 v41, v41
    v_smfmac_f32_32x32x32_bf16 v[48:63], v[80:83], v[32:39], v2
    ds_read_b128 v[80:83], v4 offset:59856
    s_add_u32 s38, s38, 0x4000
    s_and_b32 s38, s38, 0x1ffff
    s_add_u32 m0, s41, 115584
    s_add_u32 s76, s38, s39
    buffer_load_dwordx4 v6, s[44:47], s76 offen sc1 lds
    buffer_load_dwordx4 v6, s[44:47], s76 offen offset:1024 sc1 lds
    buffer_load_dwordx4 v[148:151], v6, s[44:47], s69 offen offset:1024 sc1
    v_exp_f32 v42, v42
    v_exp_f32 v43, v43
    v_exp_f32 v44, v44
    v_exp_f32 v45, v45
    v_exp_f32 v46, v46
    v_exp_f32 v47, v47
    v_exp_f32 v16, v16
    s_waitcnt lgkmcnt(1)
    v_exp_f32 v17, v17
    v_smfmac_f32_32x32x32_bf16 v[48:63], v[72:75], v[40:47], v2
    ds_read_b128 v[72:75], v5 offset:57792
    v_exp_f32 v18, v18
    v_exp_f32 v19, v19
    v_exp_f32 v20, v20
    v_mfma_f32_32x32x16_bf16 v[32:47], v[68:71], v[64:67], 0
    ds_read_b128 v[68:71], v3 offset:61920
    v_exp_f32 v21, v21
    v_exp_f32 v22, v22
    v_exp_f32 v23, v23
    v_exp_f32 v24, v24
    v_exp_f32 v25, v25
    v_smfmac_f32_32x32x32_bf16 v[48:63], v[76:79], v[16:23], v2
    ds_read_b128 v[76:79], v4 offset:61920
    buffer_load_dwordx4 v[152:155], v6, s[44:47], s69 offen offset:2048 sc1
    v_exp_f32 v26, v26
    v_exp_f32 v27, v27
    v_exp_f32 v28, v28
    v_exp_f32 v29, v29
    v_exp_f32 v30, v30
    v_exp_f32 v31, v31
    v_exp_f32 v32, v32
    s_waitcnt lgkmcnt(1)
    v_exp_f32 v33, v33
    v_smfmac_f32_32x32x32_bf16 v[48:63], v[72:75], v[24:31], v2
    ds_read_b128 v[72:75], v5 offset:59856
    v_exp_f32 v34, v34
    v_exp_f32 v35, v35
    v_exp_f32 v36, v36
    v_mfma_f32_32x32x16_bf16 v[16:31], v[68:71], v[64:67], 0
    ds_read_b128 v[68:71], v3 offset:63984
    v_exp_f32 v37, v37
    v_exp_f32 v38, v38
    v_exp_f32 v39, v39
    v_exp_f32 v40, v40
    v_exp_f32 v41, v41
    v_smfmac_f32_32x32x32_bf16 v[48:63], v[80:83], v[32:39], v2
    ds_read_b128 v[80:83], v4 offset:63984
    buffer_load_dwordx4 v[156:159], v6, s[44:47], s69 offen offset:3072 sc1
    s_add_u32 s69, s69, 4096
    v_exp_f32 v42, v42
    v_exp_f32 v43, v43
    v_exp_f32 v44, v44
    v_exp_f32 v45, v45
    v_exp_f32 v46, v46
    v_exp_f32 v47, v47
    s_setprio 2
    s_lshr_b32 s76, s61, 2
    s_lshl3_add_u32 s76, s76, s3
    s_cmp_lg_u32 s76, 62
    s_cbranch_scc0 L_rare_47
L_back_48:
    v_exp_f32 v16, v16
    s_waitcnt lgkmcnt(1)
    v_exp_f32 v17, v17
    v_smfmac_f32_32x32x32_bf16 v[48:63], v[72:75], v[40:47], v2
    ds_read_b128 v[72:75], v5 offset:61920
    v_exp_f32 v18, v18
    v_exp_f32 v19, v19
    v_exp_f32 v20, v20
    v_mfma_f32_32x32x16_bf16 v[32:47], v[68:71], v[64:67], 0
    v_add_u32 v3, 66048, v3
    ds_read_b128 v[68:71], v3 offset:0
    v_exp_f32 v21, v21
    v_exp_f32 v22, v22
    v_exp_f32 v23, v23
    v_exp_f32 v24, v24
    v_exp_f32 v25, v25
    v_smfmac_f32_32x32x32_bf16 v[48:63], v[76:79], v[16:23], v2
    v_add_u32 v4, 66048, v4
    ds_read_b128 v[76:79], v4 offset:0
    buffer_load_dwordx4 v[160:163], v6, s[44:47], s69 offen sc1
    v_exp_f32 v26, v26
    v_exp_f32 v27, v27
    v_exp_f32 v28, v28
    v_exp_f32 v29, v29
    v_exp_f32 v30, v30
    v_exp_f32 v31, v31
    v_exp_f32 v32, v32
    s_waitcnt lgkmcnt(1)
    v_exp_f32 v33, v33
    v_smfmac_f32_32x32x32_bf16 v[48:63], v[72:75], v[24:31], v2
    ds_read_b128 v[72:75], v5 offset:63984
    v_exp_f32 v34, v34
    v_exp_f32 v35, v35
    v_exp_f32 v36, v36
    v_mfma_f32_32x32x16_bf16 v[16:31], v[68:71], v[64:67], 0
    ds_read_b128 v[68:71], v3 offset:2064
    v_exp_f32 v37, v37
    v_exp_f32 v38, v38
    v_exp_f32 v39, v39
    v_exp_f32 v40, v40
    v_exp_f32 v41, v41
    v_smfmac_f32_32x32x32_bf16 v[48:63], v[80:83], v[32:39], v2
    ds_read_b128 v[80:83], v4 offset:2064
    buffer_load_dwordx4 v[164:167], v6, s[44:47], s69 offen offset:1024 sc1
    v_exp_f32 v42, v42
    v_exp_f32 v43, v43
    v_exp_f32 v44, v44
    v_exp_f32 v45, v45
    v_exp_f32 v46, v46
    v_exp_f32 v47, v47
    v_exp_f32 v16, v16
    s_waitcnt lgkmcnt(1)
    v_exp_f32 v17, v17
    v_smfmac_f32_32x32x32_bf16 v[48:63], v[72:75], v[40:47], v2
    v_add_u32 v5, 66048, v5
    ds_read_b128 v[72:75], v5 offset:0
    v_exp_f32 v18, v18
    v_exp_f32 v19, v19
    v_exp_f32 v20, v20
    v_mfma_f32_32x32x16_bf16 v[32:47], v[68:71], v[64:67], 0
    ds_read_b128 v[68:71], v3 offset:4128
    v_exp_f32 v21, v21
    v_exp_f32 v22, v22
    v_exp_f32 v23, v23
    v_exp_f32 v24, v24
    v_exp_f32 v25, v25
    v_smfmac_f32_32x32x32_bf16 v[48:63], v[76:79], v[16:23], v2
    ds_read_b128 v[76:79], v4 offset:4128
    buffer_load_dwordx4 v[168:171], v6, s[44:47], s69 offen offset:2048 sc1
    v_exp_f32 v26, v26
    v_exp_f32 v27, v27
    v_exp_f32 v28, v28
    v_exp_f32 v29, v29
    v_exp_f32 v30, v30
    v_exp_f32 v31, v31
    v_exp_f32 v32, v32
    s_waitcnt lgkmcnt(1)
    v_exp_f32 v33, v33
    v_smfmac_f32_32x32x32_bf16 v[48:63], v[72:75], v[24:31], v2
    ds_read_b128 v[72:75], v5 offset:2064
    v_exp_f32 v34, v34
    v_exp_f32 v35, v35
    v_exp_f32 v36, v36
    v_mfma_f32_32x32x16_bf16 v[16:31], v[68:71], v[64:67], 0
    ds_read_b128 v[68:71], v3 offset:6192
    v_exp_f32 v37, v37
    v_exp_f32 v38, v38
    v_exp_f32 v39, v39
    v_exp_f32 v40, v40
    v_exp_f32 v41, v41
    v_smfmac_f32_32x32x32_bf16 v[48:63], v[80:83], v[32:39], v2
    ds_read_b128 v[80:83], v4 offset:6192
    buffer_load_dwordx4 v[172:175], v6, s[44:47], s69 offen offset:3072 sc1
    s_add_u32 s69, s69, 4096
    v_exp_f32 v42, v42
    v_exp_f32 v43, v43
    v_exp_f32 v44, v44
    v_exp_f32 v45, v45
    v_exp_f32 v46, v46
    v_exp_f32 v47, v47
    v_exp_f32 v16, v16
    s_waitcnt lgkmcnt(1)
    v_exp_f32 v17, v17
    v_smfmac_f32_32x32x32_bf16 v[48:63], v[72:75], v[40:47], v2
    ds_read_b128 v[72:75], v5 offset:4128
    v_exp_f32 v18, v18
    v_exp_f32 v19, v19
    v_exp_f32 v20, v20
    v_mfma_f32_32x32x16_bf16 v[32:47], v[68:71], v[64:67], 0
    ds_read_b128 v[68:71], v3 offset:8256
    v_exp_f32 v21, v21
    v_exp_f32 v22, v22
    v_exp_f32 v23, v23
    v_exp_f32 v24, v24
    v_exp_f32 v25, v25
    v_smfmac_f32_32x32x32_bf16 v[48:63], v[76:79], v[16:23], v2
    ds_read_b128 v[76:79], v4 offset:8256
    buffer_load_dwordx4 v[176:179], v6, s[44:47], s69 offen sc1
    v_exp_f32 v26, v26
    v_exp_f32 v27, v27
    v_exp_f32 v28, v28
    v_exp_f32 v29, v29
    v_exp_f32 v30, v30
    v_exp_f32 v31, v31
    v_exp_f32 v32, v32
    s_waitcnt lgkmcnt(1)
    v_exp_f32 v33, v33
    v_smfmac_f32_32x32x32_bf16 v[48:63], v[72:75], v[24:31], v2
    ds_read_b128 v[72:75], v5 offset:6192
    v_exp_f32 v34, v34
    v_exp_f32 v35, v35
    v_exp_f32 v36, v36
    v_mfma_f32_32x32x16_bf16 v[16:31], v[68:71], v[64:67], 0
    ds_read_b128 v[68:71], v3 offset:10320
    v_exp_f32 v37, v37
    v_exp_f32 v38, v38
    v_exp_f32 v39, v39
    v_exp_f32 v40, v40
    v_exp_f32 v41, v41
    v_smfmac_f32_32x32x32_bf16 v[48:63], v[80:83], v[32:39], v2
    ds_read_b128 v[80:83], v4 offset:10320
    buffer_load_dwordx4 v[180:183], v6, s[44:47], s69 offen offset:1024 sc1
    v_exp_f32 v42, v42
    v_exp_f32 v43, v43
    v_exp_f32 v44, v44
    v_exp_f32 v45, v45
    v_exp_f32 v46, v46
    v_exp_f32 v47, v47
    s_setprio 1
    v_exp_f32 v16, v16
    s_waitcnt lgkmcnt(1)
    v_exp_f32 v17, v17
    v_smfmac_f32_32x32x32_bf16 v[48:63], v[72:75], v[40:47], v2
    ds_read_b128 v[72:75], v5 offset:8256
    v_exp_f32 v18, v18
    v_exp_f32 v19, v19
    v_exp_f32 v20, v20
    v_mfma_f32_32x32x16_bf16 v[32:47], v[68:71], v[64:67], 0
    ds_read_b128 v[68:71], v3 offset:12384
    v_exp_f32 v21, v21
    v_exp_f32 v22, v22
    v_exp_f32 v23, v23
    v_exp_f32 v24, v24
    v_exp_f32 v25, v25
    v_smfmac_f32_32x32x32_bf16 v[48:63], v[76:79], v[16:23], v2
    ds_read_b128 v[76:79], v4 offset:12384
    buffer_load_dwordx4 v[184:187], v6, s[44:47], s69 offen offset:2048 sc1
    v_exp_f32 v26, v26
    v_exp_f32 v27, v27
    v_exp_f32 v28, v28
    v_exp_f32 v29, v29
    v_exp_f32 v30, v30
    v_exp_f32 v31, v31
    s_setprio 0
    v_exp_f32 v32, v32
    s_waitcnt lgkmcnt(1)
    v_exp_f32 v33, v33
    v_smfmac_f32_32x32x32_bf16 v[48:63], v[72:75], v[24:31], v2
    ds_read_b128 v[72:75], v5 offset:10320
    v_exp_f32 v34, v34
    v_exp_f32 v35, v35
    v_exp_f32 v36, v36
    v_mfma_f32_32x32x16_bf16 v[16:31], v[68:71], v[64:67], 0
    ds_read_b128 v[68:71], v3 offset:14448
    v_exp_f32 v37, v37
    v_exp_f32 v38, v38
    v_exp_f32 v39, v39
    v_exp_f32 v40, v40
    v_exp_f32 v41, v41
    v_smfmac_f32_32x32x32_bf16 v[48:63], v[80:83], v[32:39], v2
    ds_read_b128 v[80:83], v4 offset:14448
    buffer_load_dwordx4 v[188:191], v6, s[44:47], s69 offen offset:3072 sc1
    s_add_u32 s69, s69, 4096
    v_exp_f32 v42, v42
    v_exp_f32 v43, v43
    v_exp_f32 v44, v44
    v_exp_f32 v45, v45
    v_exp_f32 v46, v46
    v_exp_f32 v47, v47
    s_waitcnt vmcnt(11)
    s_barrier
    s_setprio 3
    v_exp_f32 v16, v16
    s_waitcnt lgkmcnt(1)
    v_exp_f32 v17, v17
    v_smfmac_f32_32x32x32_bf16 v[48:63], v[72:75], v[40:47], v2
    ds_read_b128 v[72:75], v5 offset:12384
    v_exp_f32 v18, v18
    v_exp_f32 v19, v19
    v_exp_f32 v20, v20
    v_mfma_f32_32x32x16_bf16 v[32:47], v[68:71], v[64:67], 0
    ds_read_b128 v[68:71], v3 offset:16512
    v_exp_f32 v21, v21
    v_exp_f32 v22, v22
    v_exp_f32 v23, v23
    v_exp_f32 v24, v24
    v_exp_f32 v25, v25
    v_smfmac_f32_32x32x32_bf16 v[48:63], v[76:79], v[16:23], v2
    ds_read_b128 v[76:79], v4 offset:16512
    buffer_load_dwordx4 v[192:195], v6, s[44:47], s70 offen sc1
    v_exp_f32 v26, v26
    v_exp_f32 v27, v27
    v_exp_f32 v28, v28
    v_exp_f32 v29, v29
    v_exp_f32 v30, v30
    v_exp_f32 v31, v31
    v_exp_f32 v32, v32
    s_waitcnt lgkmcnt(1)
    v_exp_f32 v33, v33
    v_smfmac_f32_32x32x32_bf16 v[48:63], v[72:75], v[24:31], v2
    ds_read_b128 v[72:75], v5 offset:14448
    v_exp_f32 v34, v34
    v_exp_f32 v35, v35
    v_exp_f32 v36, v36
    v_mfma_f32_32x32x16_bf16 v[16:31], v[68:71], v[64:67], 0
    ds_read_b128 v[68:71], v3 offset:18576
    v_exp_f32 v37, v37
    v_exp_f32 v38, v38
    v_exp_f32 v39, v39
    v_exp_f32 v40, v40
    v_exp_f32 v41, v41
    v_smfmac_f32_32x32x32_bf16 v[48:63], v[80:83], v[32:39], v2
    ds_read_b128 v[80:83], v4 offset:18576
    buffer_load_dwordx4 v[196:199], v6, s[44:47], s70 offen offset:1024 sc1
    v_exp_f32 v42, v42
    v_exp_f32 v43, v43
    v_exp_f32 v44, v44
    v_exp_f32 v45, v45
    v_exp_f32 v46, v46
    v_exp_f32 v47, v47
    v_exp_f32 v16, v16
    s_waitcnt lgkmcnt(1)
    v_exp_f32 v17, v17
    v_smfmac_f32_32x32x32_bf16 v[48:63], v[72:75], v[40:47], v2
    ds_read_b128 v[72:75], v5 offset:16512
    v_exp_f32 v18, v18
    v_exp_f32 v19, v19
    v_exp_f32 v20, v20
    v_mfma_f32_32x32x16_bf16 v[32:47], v[68:71], v[64:67], 0
    ds_read_b128 v[68:71], v3 offset:20640
    v_exp_f32 v21, v21
    v_exp_f32 v22, v22
    v_exp_f32 v23, v23
    v_exp_f32 v24, v24
    v_exp_f32 v25, v25
    v_smfmac_f32_32x32x32_bf16 v[48:63], v[76:79], v[16:23], v2
    ds_read_b128 v[76:79], v4 offset:20640
    buffer_load_dwordx4 v[200:203], v6, s[44:47], s70 offen offset:2048 sc1
    v_exp_f32 v26, v26
    v_exp_f32 v27, v27
    v_exp_f32 v28, v28
    v_exp_f32 v29, v29
    v_exp_f32 v30, v30
    v_exp_f32 v31, v31
    s_cmp_lt_u32 s3, 4
    s_cbranch_scc1 L_skip_51
    v_lshlrev_b32 v87, 10, v8
    v_lshl_add_u32 v87, v7, 3, v87
    s_lshl2_add_u32 s76, s60, s63
    s_lshl_b32 s76, s76, 16
    s_lshl2_add_u32 s77, s64, s3
    s_lshl_b32 s77, s77, 5
    s_add_u32 s76, s76, s77
    s_sub_u32 s76, s76, 128
    buffer_load_dwordx2 v[92:93], v87, s[28:31], s76 offen
    s_add_u32 s76, s76, 16384
    buffer_load_dwordx2 v[94:95], v87, s[28:31], s76 offen
    s_add_u32 s76, s76, 16384
    buffer_load_dwordx2 v[96:97], v87, s[28:31], s76 offen
    s_add_u32 s76, s76, 16384
    buffer_load_dwordx2 v[98:99], v87, s[28:31], s76 offen
L_skip_51:
    v_exp_f32 v32, v32
    s_waitcnt lgkmcnt(1)
    v_exp_f32 v33, v33
    v_smfmac_f32_32x32x32_bf16 v[48:63], v[72:75], v[24:31], v2
    ds_read_b128 v[72:75], v5 offset:18576
    v_exp_f32 v34, v34
    v_exp_f32 v35, v35
    v_exp_f32 v36, v36
    v_mfma_f32_32x32x16_bf16 v[16:31], v[68:71], v[64:67], 0
    ds_read_b128 v[68:71], v3 offset:22704
    v_exp_f32 v37, v37
    v_exp_f32 v38, v38
    v_exp_f32 v39, v39
    v_exp_f32 v40, v40
    v_exp_f32 v41, v41
    v_smfmac_f32_32x32x32_bf16 v[48:63], v[80:83], v[32:39], v2
    ds_read_b128 v[80:83], v4 offset:22704
    buffer_load_dwordx4 v[204:207], v6, s[44:47], s70 offen offset:3072 sc1
    s_add_u32 s70, s70, 4096
    v_exp_f32 v42, v42
    v_exp_f32 v43, v43
    v_exp_f32 v44, v44
    v_exp_f32 v45, v45
    v_exp_f32 v46, v46
    v_exp_f32 v47, v47
    v_exp_f32 v16, v16
    s_waitcnt lgkmcnt(1)
    v_exp_f32 v17, v17
    v_smfmac_f32_32x32x32_bf16 v[48:63], v[72:75], v[40:47], v2
    ds_read_b128 v[72:75], v5 offset:20640
    v_exp_f32 v18, v18
    v_exp_f32 v19, v19
    v_exp_f32 v20, v20
    v_mfma_f32_32x32x16_bf16 v[32:47], v[68:71], v[64:67], 0
    ds_read_b128 v[68:71], v3 offset:24768
    v_exp_f32 v21, v21
    v_exp_f32 v22, v22
    v_exp_f32 v23, v23
    v_exp_f32 v24, v24
    v_exp_f32 v25, v25
    v_smfmac_f32_32x32x32_bf16 v[48:63], v[76:79], v[16:23], v2
    ds_read_b128 v[76:79], v4 offset:24768
    buffer_load_dwordx4 v[208:211], v6, s[44:47], s70 offen sc1
    v_exp_f32 v26, v26
    v_exp_f32 v27, v27
    v_exp_f32 v28, v28
    v_exp_f32 v29, v29
    v_exp_f32 v30, v30
    v_exp_f32 v31, v31
    v_exp_f32 v32, v32
    s_waitcnt lgkmcnt(1)
    v_exp_f32 v33, v33
    v_smfmac_f32_32x32x32_bf16 v[48:63], v[72:75], v[24:31], v2
    ds_read_b128 v[72:75], v5 offset:22704
    v_exp_f32 v34, v34
    v_exp_f32 v35, v35
    v_exp_f32 v36, v36
    v_mfma_f32_32x32x16_bf16 v[16:31], v[68:71], v[64:67], 0
    ds_read_b128 v[68:71], v3 offset:26832
    v_exp_f32 v37, v37
    v_exp_f32 v38, v38
    v_exp_f32 v39, v39
    v_exp_f32 v40, v40
    v_exp_f32 v41, v41
    v_smfmac_f32_32x32x32_bf16 v[48:63], v[80:83], v[32:39], v2
    ds_read_b128 v[80:83], v4 offset:26832
    buffer_load_dwordx4 v[212:215], v6, s[44:47], s70 offen offset:1024 sc1
    v_exp_f32 v42, v42
    v_exp_f32 v43, v43
    v_exp_f32 v44, v44
    v_exp_f32 v45, v45
    v_exp_f32 v46, v46
    v_exp_f32 v47, v47
    s_cmp_lg_u32 s3, 3
    s_cbranch_scc0 L_rare_52
L_back_53:
    v_exp_f32 v16, v16
    s_waitcnt lgkmcnt(1)
    v_exp_f32 v17, v17
    v_smfmac_f32_32x32x32_bf16 v[48:63], v[72:75], v[40:47], v2
    ds_read_b128 v[72:75], v5 offset:24768
    v_exp_f32 v18, v18
    v_exp_f32 v19, v19
    v_exp_f32 v20, v20
    v_mfma_f32_32x32x16_bf16 v[32:47], v[68:71], v[64:67], 0
    ds_read_b128 v[68:71], v3 offset:28896
    v_exp_f32 v21, v21
    v_exp_f32 v22, v22
    v_exp_f32 v23, v23
    v_exp_f32 v24, v24
    v_exp_f32 v25, v25
    v_smfmac_f32_32x32x32_bf16 v[48:63], v[76:79], v[16:23], v2
    ds_read_b128 v[76:79], v4 offset:28896
    buffer_load_dwordx4 v[216:219], v6, s[44:47], s70 offen offset:2048 sc1
    s_lshl_b32 s27, s3, 8
    s_add_u32 s27, s27, 10240
    buffer_load_dwordx2 v[108:109], v13, s[44:47], s27 offen sc1
    v_exp_f32 v26, v26
    v_exp_f32 v27, v27
    v_exp_f32 v28, v28
    v_exp_f32 v29, v29
    v_exp_f32 v30, v30
    v_exp_f32 v31, v31
    v_exp_f32 v32, v32
    s_waitcnt lgkmcnt(1)
    v_exp_f32 v33, v33
    v_smfmac_f32_32x32x32_bf16 v[48:63], v[72:75], v[24:31], v2
    ds_read_b128 v[72:75], v5 offset:26832
    v_exp_f32 v34, v34
    v_exp_f32 v35, v35
    v_exp_f32 v36, v36
    v_mfma_f32_32x32x16_bf16 v[16:31], v[68:71], v[64:67], 0
    ds_read_b128 v[68:71], v3 offset:30960
    v_exp_f32 v37, v37
    v_exp_f32 v38, v38
    v_exp_f32 v39, v39
    v_exp_f32 v40, v40
    v_exp_f32 v41, v41
    v_smfmac_f32_32x32x32_bf16 v[48:63], v[80:83], v[32:39], v2
    ds_read_b128 v[80:83], v4 offset:30960
    buffer_load_dwordx4 v[220:223], v6, s[44:47], s70 offen offset:3072 sc1
    s_add_u32 s70, s70, 4096
    v_exp_f32 v42, v42
    v_exp_f32 v43, v43
    v_exp_f32 v44, v44
    v_exp_f32 v45, v45
    v_exp_f32 v46, v46
    v_exp_f32 v47, v47
    v_exp_f32 v16, v16
    s_waitcnt lgkmcnt(1)
    v_exp_f32 v17, v17
    v_smfmac_f32_32x32x32_bf16 v[48:63], v[72:75], v[40:47], v2
    ds_read_b128 v[72:75], v5 offset:28896
    v_exp_f32 v18, v18
    v_exp_f32 v19, v19
    v_exp_f32 v20, v20
    v_mfma_f32_32x32x16_bf16 v[32:47], v[68:71], v[64:67], 0
    ds_read_b128 v[68:71], v3 offset:33024
    v_exp_f32 v21, v21
    v_exp_f32 v22, v22
    v_exp_f32 v23, v23
    v_exp_f32 v24, v24
    v_exp_f32 v25, v25
    v_smfmac_f32_32x32x32_bf16 v[48:63], v[76:79], v[16:23], v2
    ds_read_b128 v[76:79], v4 offset:33024
    buffer_load_dwordx4 v[224:227], v6, s[44:47], s70 offen sc1
    v_exp_f32 v26, v26
    v_exp_f32 v27, v27
    v_exp_f32 v28, v28
    v_exp_f32 v29, v29
    v_exp_f32 v30, v30
    v_exp_f32 v31, v31
    v_exp_f32 v32, v32
    s_waitcnt lgkmcnt(1)
    v_exp_f32 v33, v33
    v_smfmac_f32_32x32x32_bf16 v[48:63], v[72:75], v[24:31], v2
    ds_read_b128 v[72:75], v5 offset:30960
    v_exp_f32 v34, v34
    v_exp_f32 v35, v35
    v_exp_f32 v36, v36
    v_mfma_f32_32x32x16_bf16 v[16:31], v[68:71], v[64:67], 0
    ds_read_b128 v[68:71], v3 offset:35088
    v_exp_f32 v37, v37
    v_exp_f32 v38, v38
    v_exp_f32 v39, v39
    v_exp_f32 v40, v40
    v_exp_f32 v41, v41
    v_smfmac_f32_32x32x32_bf16 v[48:63], v[80:83], v[32:39], v2
    ds_read_b128 v[80:83], v4 offset:35088
    buffer_load_dwordx4 v[228:231], v6, s[44:47], s70 offen offset:1024 sc1
    v_exp_f32 v42, v42
    v_exp_f32 v43, v43
    v_exp_f32 v44, v44
    v_exp_f32 v45, v45
    v_exp_f32 v46, v46
    v_exp_f32 v47, v47
    v_exp_f32 v16, v16
    s_waitcnt lgkmcnt(1)
    v_exp_f32 v17, v17
    v_smfmac_f32_32x32x32_bf16 v[48:63], v[72:75], v[40:47], v2
    ds_read_b128 v[72:75], v5 offset:33024
    v_exp_f32 v18, v18
    v_exp_f32 v19, v19
    v_exp_f32 v20, v20
    v_mfma_f32_32x32x16_bf16 v[32:47], v[68:71], v[64:67], 0
    ds_read_b128 v[68:71], v3 offset:37152
    v_exp_f32 v21, v21
    v_exp_f32 v22, v22
    v_exp_f32 v23, v23
    v_exp_f32 v24, v24
    v_exp_f32 v25, v25
    v_smfmac_f32_32x32x32_bf16 v[48:63], v[76:79], v[16:23], v2
    ds_read_b128 v[76:79], v4 offset:37152
    buffer_load_dwordx4 v[232:235], v6, s[44:47], s70 offen offset:2048 sc1
    v_exp_f32 v26, v26
    v_exp_f32 v27, v27
    v_exp_f32 v28, v28
    v_exp_f32 v29, v29
    v_exp_f32 v30, v30
    v_exp_f32 v31, v31
    v_exp_f32 v32, v32
    s_waitcnt lgkmcnt(1)
    v_exp_f32 v33, v33
    v_smfmac_f32_32x32x32_bf16 v[48:63], v[72:75], v[24:31], v2
    ds_read_b128 v[72:75], v5 offset:35088
    v_exp_f32 v34, v34
    v_exp_f32 v35, v35
    v_exp_f32 v36, v36
    v_mfma_f32_32x32x16_bf16 v[16:31], v[68:71], v[64:67], 0
    ds_read_b128 v[68:71], v3 offset:39216
    v_exp_f32 v37, v37
    v_exp_f32 v38, v38
    v_exp_f32 v39, v39
    v_exp_f32 v40, v40
    v_exp_f32 v41, v41
    v_smfmac_f32_32x32x32_bf16 v[48:63], v[80:83], v[32:39], v2
    ds_read_b128 v[80:83], v4 offset:39216
    buffer_load_dwordx4 v[236:239], v6, s[44:47], s70 offen offset:3072 sc1
    s_add_u32 s70, s70, 4096
    v_exp_f32 v42, v42
    v_exp_f32 v43, v43
    v_exp_f32 v44, v44
    v_exp_f32 v45, v45
    v_exp_f32 v46, v46
    v_exp_f32 v47, v47
    s_waitcnt vmcnt(5)
    v_cmp_ne_u32 vcc, s62, v109
    s_nop 0
    s_cbranch_vccnz L_again_55
L_ok_54:
    v_lshrrev_b32 v110, 5, v0
    v_mul_u32_u24 v110, 960, v110
    v_lshl_add_u32 v110, v0, 2, v110
    s_lshl_b32 s76, s3, 7
    s_add_u32 s76, s76, 150528
    v_add_u32 v110, s76, v110
    ds_write_b32 v110, v108
    s_cmp_lg_u32 s3, 3
    s_cbranch_scc0 L_rare_58
L_back_59:
    v_exp_f32 v16, v16
    s_waitcnt lgkmcnt(2)
    v_exp_f32 v17, v17
    v_smfmac_f32_32x32x32_bf16 v[48:63], v[72:75], v[40:47], v2
    ds_read_b128 v[72:75], v5 offset:37152
    v_exp_f32 v18, v18
    v_exp_f32 v19, v19
    v_exp_f32 v20, v20
    v_mfma_f32_32x32x16_bf16 v[32:47], v[68:71], v[64:67], 0
    ds_read_b128 v[68:71], v3 offset:41280
    v_exp_f32 v21, v21
    v_exp_f32 v22, v22
    v_exp_f32 v23, v23
    v_exp_f32 v24, v24
    v_exp_f32 v25, v25
    v_smfmac_f32_32x32x32_bf16 v[48:63], v[76:79], v[16:23], v2
    ds_read_b128 v[76:79], v4 offset:41280
    buffer_load_dwordx4 v[240:243], v6, s[44:47], s70 offen sc1
    v_exp_f32 v26, v26
    v_exp_f32 v27, v27
    v_exp_f32 v28, v28
    v_exp_f32 v29, v29
    v_exp_f32 v30, v30
    v_exp_f32 v31, v31
    s_setprio 2
    v_exp_f32 v32, v32
    s_waitcnt lgkmcnt(1)
    v_exp_f32 v33, v33
    v_smfmac_f32_32x32x32_bf16 v[48:63], v[72:75], v[24:31], v2
    ds_read_b128 v[72:75], v5 offset:39216
    v_exp_f32 v34, v34
    v_exp_f32 v35, v35
    v_exp_f32 v36, v36
    v_mfma_f32_32x32x16_bf16 v[16:31], v[68:71], v[64:67], 0
    ds_read_b128 v[68:71], v3 offset:43344
    v_exp_f32 v37, v37
    v_exp_f32 v38, v38
    v_exp_f32 v39, v39
    v_exp_f32 v40, v40
    v_exp_f32 v41, v41
    v_smfmac_f32_32x32x32_bf16 v[48:63], v[80:83], v[32:39], v2
    ds_read_b128 v[80:83], v4 offset:43344
    buffer_load_dwordx4 v[244:247], v6, s[44:47], s70 offen offset:1024 sc1
    v_exp_f32 v42, v42
    v_exp_f32 v43, v43
    v_exp_f32 v44, v44
    v_exp_f32 v45, v45
    v_exp_f32 v46, v46
    v_exp_f32 v47, v47
    v_exp_f32 v16, v16
    s_waitcnt lgkmcnt(1)
    v_exp_f32 v17, v17
    v_smfmac_f32_32x32x32_bf16 v[48:63], v[72:75], v[40:47], v2
    ds_read_b128 v[72:75], v5 offset:41280
    v_exp_f32 v18, v18
    v_exp_f32 v19, v19
    v_exp_f32 v20, v20
    v_mfma_f32_32x32x16_bf16 v[32:47], v[68:71], v[64:67], 0
    ds_read_b128 v[68:71], v3 offset:45408
    v_exp_f32 v21, v21
    v_exp_f32 v22, v22
    v_exp_f32 v23, v23
    v_exp_f32 v24, v24
    v_exp_f32 v25, v25
    v_smfmac_f32_32x32x32_bf16 v[48:63], v[76:79], v[16:23], v2
    ds_read_b128 v[76:79], v4 offset:45408
    buffer_load_dwordx4 v[248:251], v6, s[44:47], s70 offen offset:2048 sc1
    v_exp_f32 v26, v26
    v_exp_f32 v27, v27
    v_exp_f32 v28, v28
    v_exp_f32 v29, v29
    v_exp_f32 v30, v30
    v_exp_f32 v31, v31
    v_exp_f32 v32, v32
    s_waitcnt lgkmcnt(1)
    v_exp_f32 v33, v33
    v_smfmac_f32_32x32x32_bf16 v[48:63], v[72:75], v[24:31], v2
    ds_read_b128 v[72:75], v5 offset:43344
    v_exp_f32 v34, v34
    v_exp_f32 v35, v35
    v_exp_f32 v36, v36
    v_mfma_f32_32x32x16_bf16 v[16:31], v[68:71], v[64:67], 0
    ds_read_b128 v[68:71], v3 offset:47472
    v_exp_f32 v37, v37
    v_exp_f32 v38, v38
    v_exp_f32 v39, v39
    v_exp_f32 v40, v40
    v_exp_f32 v41, v41
    v_smfmac_f32_32x32x32_bf16 v[48:63], v[80:83], v[32:39], v2
    ds_read_b128 v[80:83], v4 offset:47472
    buffer_load_dwordx4 v[252:255], v6, s[44:47], s70 offen offset:3072 sc1
    s_add_u32 s70, s70, 4096
    v_exp_f32 v42, v42
    v_exp_f32 v43, v43
    v_exp_f32 v44, v44
    v_exp_f32 v45, v45
    v_exp_f32 v46, v46
    v_exp_f32 v47, v47
    s_cmp_eq_u32 s66, 0
    s_cbranch_scc1 L_skip_64
    s_lshl_b32 s76, s61, 3
    s_add_u32 s76, s76, s3
    v_min_u32 v111, 39, v0
    v_lshlrev_b32 v111, 7, v111
    s_mul_i32 s76, s76, 5120
    s_add_u32 s76, s76, s65
    buffer_load_dword v107, v111, s[44:47], s76 offen sc1
L_skip_64:
    v_exp_f32 v16, v16
    s_waitcnt lgkmcnt(1)
    v_exp_f32 v17, v17
    v_smfmac_f32_32x32x32_bf16 v[48:63], v[72:75], v[40:47], v2
    ds_read_b128 v[72:75], v5 offset:45408
    v_exp_f32 v18, v18
    v_exp_f32 v19, v19
    v_exp_f32 v20, v20
    v_mfma_f32_32x32x16_bf16 v[32:47], v[68:71], v[64:67], 0
    ds_read_b128 v[68:71], v3 offset:49536
    v_exp_f32 v21, v21
    v_exp_f32 v22, v22
    v_exp_f32 v23, v23
    v_exp_f32 v24, v24
    v_exp_f32 v25, v25
    v_smfmac_f32_32x32x32_bf16 v[48:63], v[76:79], v[16:23], v2
    ds_read_b128 v[76:79], v4 offset:49536
    v_exp_f32 v26, v26
    v_exp_f32 v27, v27
    v_exp_f32 v28, v28
    v_exp_f32 v29, v29
    v_exp_f32 v30, v30
    v_exp_f32 v31, v31
    v_exp_f32 v32, v32
    s_waitcnt lgkmcnt(1)
    v_exp_f32 v33, v33
    v_smfmac_f32_32x32x32_bf16 v[48:63], v[72:75], v[24:31], v2
    ds_read_b128 v[72:75], v5 offset:47472
    v_exp_f32 v34, v34
    v_exp_f32 v35, v35
    v_exp_f32 v36, v36
    v_mfma_f32_32x32x16_bf16 v[16:31], v[68:71], v[64:67], 0
    ds_read_b128 v[68:71], v3 offset:51600
    v_exp_f32 v37, v37
    v_exp_f32 v38, v38
    v_exp_f32 v39, v39
    v_exp_f32 v40, v40
    v_exp_f32 v41, v41
    v_smfmac_f32_32x32x32_bf16 v[48:63], v[80:83], v[32:39], v2
    ds_read_b128 v[80:83], v4 offset:51600
    v_exp_f32 v42, v42
    v_exp_f32 v43, v43
    v_exp_f32 v44, v44
    v_exp_f32 v45, v45
    v_exp_f32 v46, v46
    v_exp_f32 v47, v47
    v_exp_f32 v16, v16
    s_waitcnt lgkmcnt(1)
    v_exp_f32 v17, v17
    v_smfmac_f32_32x32x32_bf16 v[48:63], v[72:75], v[40:47], v2
    ds_read_b128 v[72:75], v5 offset:49536
    v_exp_f32 v18, v18
    v_exp_f32 v19, v19
    v_exp_f32 v20, v20
    v_mfma_f32_32x32x16_bf16 v[32:47], v[68:71], v[64:67], 0
    ds_read_b128 v[68:71], v3 offset:53664
    v_exp_f32 v21, v21
    v_exp_f32 v22, v22
    v_exp_f32 v23, v23
    v_exp_f32 v24, v24
    v_exp_f32 v25, v25
    v_smfmac_f32_32x32x32_bf16 v[48:63], v[76:79], v[16:23], v2
    ds_read_b128 v[76:79], v4 offset:53664
    v_exp_f32 v26, v26
    v_exp_f32 v27, v27
    v_exp_f32 v28, v28
    v_exp_f32 v29, v29
    v_exp_f32 v30, v30
    v_exp_f32 v31, v31
    s_lshl_b32 s76, s61, 3
    s_add_u32 s76, s76, s3
    s_lshl_b32 s77, s76, 7
    s_add_u32 s77, s77, L_attn_done-L_pc
    s_mov_b64 exec, 1
    buffer_load_dword v1, v6, s[56:59], s77 offen
    s_mov_b64 exec, -1
    v_exp_f32 v32, v32
    s_waitcnt lgkmcnt(1)
    v_exp_f32 v33, v33
    v_smfmac_f32_32x32x32_bf16 v[48:63], v[72:75], v[24:31], v2
    ds_read_b128 v[72:75], v5 offset:51600
    v_exp_f32 v34, v34
    v_exp_f32 v35, v35
    v_exp_f32 v36, v36
    v_mfma_f32_32x32x16_bf16 v[16:31], v[68:71], v[64:67], 0
    ds_read_b128 v[68:71], v3 offset:55728
    v_exp_f32 v37, v37
    v_exp_f32 v38, v38
    v_exp_f32 v39, v39
    v_exp_f32 v40, v40
    v_exp_f32 v41, v41
    v_smfmac_f32_32x32x32_bf16 v[48:63], v[80:83], v[32:39], v2
    ds_read_b128 v[80:83], v4 offset:55728
    v_exp_f32 v42, v42
    v_exp_f32 v43, v43
    v_exp_f32 v44, v44
    v_exp_f32 v45, v45
    v_exp_f32 v46, v46
    v_exp_f32 v47, v47
    v_exp_f32 v16, v16
    s_waitcnt lgkmcnt(1)
    v_exp_f32 v17, v17
    v_smfmac_f32_32x32x32_bf16 v[48:63], v[72:75], v[40:47], v2
    ds_read_b128 v[72:75], v5 offset:53664
    v_exp_f32 v18, v18
    v_exp_f32 v19, v19
    v_exp_f32 v20, v20
    v_mfma_f32_32x32x16_bf16 v[32:47], v[68:71], v[64:67], 0
    ds_read_b128 v[68:71], v3 offset:57792
    v_exp_f32 v21, v21
    v_exp_f32 v22, v22
    v_exp_f32 v23, v23
    v_exp_f32 v24, v24
    v_exp_f32 v25, v25
    v_smfmac_f32_32x32x32_bf16 v[48:63], v[76:79], v[16:23], v2
    ds_read_b128 v[76:79], v4 offset:57792
    v_exp_f32 v26, v26
    v_exp_f32 v27, v27
    v_exp_f32 v28, v28
    v_exp_f32 v29, v29
    v_exp_f32 v30, v30
    v_exp_f32 v31, v31
    v_exp_f32 v32, v32
    s_waitcnt lgkmcnt(1)
    v_exp_f32 v33, v33
    v_smfmac_f32_32x32x32_bf16 v[48:63], v[72:75], v[24:31], v2
    ds_read_b128 v[72:75], v5 offset:55728
    v_exp_f32 v34, v34
    v_exp_f32 v35, v35
    v_exp_f32 v36, v36
    v_mfma_f32_32x32x16_bf16 v[16:31], v[68:71], v[64:67], 0
    ds_read_b128 v[68:71], v3 offset:59856
    v_exp_f32 v37, v37
    v_exp_f32 v38, v38
    v_exp_f32 v39, v39
    v_exp_f32 v40, v40
    v_exp_f32 v41, v41
    v_smfmac_f32_32x32x32_bf16 v[48:63], v[80:83], v[32:39], v2
    ds_read_b128 v[80:83], v4 offset:59856
    v_exp_f32 v42, v42
    v_exp_f32 v43, v43
    v_exp_f32 v44, v44
    v_exp_f32 v45, v45
    v_exp_f32 v46, v46
    v_exp_f32 v47, v47
    s_setprio 1
    v_exp_f32 v16, v16
    s_waitcnt lgkmcnt(1)
    v_exp_f32 v17, v17
    v_smfmac_f32_32x32x32_bf16 v[48:63], v[72:75], v[40:47], v2
    ds_read_b128 v[72:75], v5 offset:57792
    v_exp_f32 v18, v18
    v_exp_f32 v19, v19
    v_exp_f32 v20, v20
    v_mfma_f32_32x32x16_bf16 v[32:47], v[68:71], v[64:67], 0
    ds_read_b128 v[68:71], v3 offset:61920
    v_exp_f32 v21, v21
    v_exp_f32 v22, v22
    v_exp_f32 v23, v23
    v_exp_f32 v24, v24
    v_exp_f32 v25, v25
    v_smfmac_f32_32x32x32_bf16 v[48:63], v[76:79], v[16:23], v2
    ds_read_b128 v[76:79], v4 offset:61920
    v_exp_f32 v26, v26
    v_exp_f32 v27, v27
    v_exp_f32 v28, v28
    v_exp_f32 v29, v29
    v_exp_f32 v30, v30
    v_exp_f32 v31, v31
    v_exp_f32 v32, v32
    s_waitcnt lgkmcnt(1)
    v_exp_f32 v33, v33
    v_smfmac_f32_32x32x32_bf16 v[48:63], v[72:75], v[24:31], v2
    ds_read_b128 v[72:75], v5 offset:59856
    v_exp_f32 v34, v34
    v_exp_f32 v35, v35
    v_exp_f32 v36, v36
    v_mfma_f32_32x32x16_bf16 v[16:31], v[68:71], v[64:67], 0
    ds_read_b128 v[68:71], v3 offset:63984
    v_exp_f32 v37, v37
    v_exp_f32 v38, v38
    v_exp_f32 v39, v39
    v_exp_f32 v40, v40
    v_exp_f32 v41, v41
    v_smfmac_f32_32x32x32_bf16 v[48:63], v[80:83], v[32:39], v2
    ds_read_b128 v[80:83], v4 offset:63984
    v_exp_f32 v42, v42
    v_exp_f32 v43, v43
    v_exp_f32 v44, v44
    v_exp_f32 v45, v45
    v_exp_f32 v46, v46
    v_exp_f32 v47, v47
    v_exp_f32 v16, v16
    s_waitcnt lgkmcnt(1)
    v_exp_f32 v17, v17
    v_smfmac_f32_32x32x32_bf16 v[48:63], v[72:75], v[40:47], v2
    ds_read_b128 v[72:75], v5 offset:61920
    v_exp_f32 v18, v18
    v_exp_f32 v19, v19
    v_exp_f32 v20, v20
    v_mfma_f32_32x32x16_bf16 v[32:47], v[68:71], v[64:67], 0
    v_exp_f32 v21, v21
    v_exp_f32 v22, v22
    v_exp_f32 v23, v23
    v_exp_f32 v24, v24
    v_exp_f32 v25, v25
    v_smfmac_f32_32x32x32_bf16 v[48:63], v[76:79], v[16:23], v2
    v_exp_f32 v26, v26
    v_exp_f32 v27, v27
    v_exp_f32 v28, v28
    v_exp_f32 v29, v29
    v_exp_f32 v30, v30
    v_exp_f32 v31, v31
    s_setprio 0
    v_exp_f32 v32, v32
    s_waitcnt lgkmcnt(0)
    v_exp_f32 v33, v33
    v_smfmac_f32_32x32x32_bf16 v[48:63], v[72:75], v[24:31], v2
    ds_read_b128 v[72:75], v5 offset:63984
    v_exp_f32 v34, v34
    v_exp_f32 v35, v35
    v_exp_f32 v36, v36
    v_exp_f32 v37, v37
    v_exp_f32 v38, v38
    v_exp_f32 v39, v39
    v_exp_f32 v40, v40
    v_exp_f32 v41, v41
    v_smfmac_f32_32x32x32_bf16 v[48:63], v[80:83], v[32:39], v2
    v_exp_f32 v42, v42
    v_exp_f32 v43, v43
    v_exp_f32 v44, v44
    v_exp_f32 v45, v45
    v_exp_f32 v46, v46
    v_exp_f32 v47, v47
    s_waitcnt lgkmcnt(0)
    s_nop 0
    v_smfmac_f32_32x32x32_bf16 v[48:63], v[72:75], v[40:47], v2
    s_setprio 0
    s_mov_b32 s76, 0x2b800000
    s_mov_b32 s77, 0x53800000
    s_nop 8
    v_mov_b32 v16, v56
    s_nop 1
    v_permlane32_swap_b32 v16, v56
    v_cmp_nle_f32 vcc, s76, v16
    v_cmp_nge_f32 s[82:83], s77, v16
    s_nop 0
    s_or_b64 vcc, vcc, s[82:83]
    s_cbranch_vccnz L_slow
L_attn_done:
    v_rcp_f32 v16, v16
    v_mov_b32 v18, s62
    s_nop 3
    v_mul_f32 v48, v16, v48
    v_mul_f32 v49, v16, v49
    v_mul_f32 v50, v16, v50
    v_mul_f32 v51, v16, v51
    v_mul_f32 v52, v16, v52
    v_mul_f32 v53, v16, v53
    v_mul_f32 v54, v16, v54
    v_mul_f32 v55, v16, v55
    v_cvt_pk_bf16_f32 v20, v48, v49
    v_cvt_pk_bf16_f32 v21, v50, v51
    v_cvt_pk_bf16_f32 v22, v52, v53
    v_cvt_pk_bf16_f32 v23, v54, v55
    s_cmp_eq_u32 s66, 0
    s_cbranch_scc1 L_safe_65
    buffer_store_dwordx4 v[20:23], v6, s[44:47], s4 offen nt
    s_waitcnt vmcnt(1)
    v_lshlrev_b32 v1, 2, v8
    v_and_b32 v11, 1, v0
    v_mul_u32_u24 v11, 1088, v11
    v_lshl_add_u32 v11, v7, 4, v11
    v_add_u32 v11, 150528, v11
    v_lshlrev_b32 v9, 9, v7
    v_lshl_add_u32 v9, v8, 4, v9
    v_add_u32 v9, 65536, v9
    v_add_u32 v10, s36, v6
    s_waitcnt vmcnt(0)
    s_mov_b64 exec, 1
    buffer_store_dword v18, v6, s[44:47], s5 offen nt
    s_mov_b64 exec, -1
L_pubd_66:
    s_waitcnt lgkmcnt(0)
    s_barrier
    s_cmp_lt_u32 s3, 4
    s_cbranch_scc1 L_cA
    s_lshl_b32 s76, s3, 5
    v_lshl_add_u32 v2, v7, 3, s76
    v_add_u32 v3, 150016, v2
    s_lshl_b32 s76, s64, 7
    s_add_u32 s76, s76, 150400
    v_add_u32 v2, s76, v2
    ds_read_b64 v[102:103], v3
    ds_read_b64 v[90:91], v2
    ds_read_b128 v[16:19], v11 offset:0
    ds_read_b128 v[20:23], v11 offset:64
    ds_read_b128 v[24:27], v11 offset:128
    ds_read_b128 v[28:31], v11 offset:192
    ds_read_b128 v[32:35], v11 offset:256
    ds_read_b128 v[36:39], v11 offset:320
    ds_read_b128 v[40:43], v11 offset:384
    ds_read_b128 v[44:47], v11 offset:448
    ds_read_b128 v[48:51], v11 offset:512
    s_waitcnt lgkmcnt(8)
    v_mfma_f32_16x16x32_bf16 v[80:83], v[192:195], v[16:19], 0
    ds_read_b128 v[52:55], v11 offset:576
    s_waitcnt lgkmcnt(8)
    v_mfma_f32_16x16x32_bf16 v[84:87], v[196:199], v[20:23], 0
    ds_read_b128 v[56:59], v11 offset:640
    s_waitcnt lgkmcnt(8)
    v_mfma_f32_16x16x32_bf16 v[80:83], v[200:203], v[24:27], v[80:83]
    ds_read_b128 v[60:63], v11 offset:704
    s_waitcnt lgkmcnt(8)
    v_mfma_f32_16x16x32_bf16 v[84:87], v[204:207], v[28:31], v[84:87]
    ds_read_b128 v[64:67], v11 offset:768
    s_waitcnt lgkmcnt(8)
    v_mfma_f32_16x16x32_bf16 v[80:83], v[208:211], v[32:35], v[80:83]
    ds_read_b128 v[68:71], v11 offset:832
    s_waitcnt lgkmcnt(8)
    v_mfma_f32_16x16x32_bf16 v[84:87], v[212:215], v[36:39], v[84:87]
    ds_read_b128 v[72:75], v11 offset:896
    s_waitcnt lgkmcnt(8)
    v_mfma_f32_16x16x32_bf16 v[80:83], v[216:219], v[40:43], v[80:83]
    ds_read_b128 v[76:79], v11 offset:960
    s_waitcnt lgkmcnt(8)
    v_mfma_f32_16x16x32_bf16 v[84:87], v[220:223], v[44:47], v[84:87]
    s_waitcnt lgkmcnt(7)
    v_mfma_f32_16x16x32_bf16 v[80:83], v[224:227], v[48:51], v[80:83]
    s_waitcnt lgkmcnt(6)
    v_mfma_f32_16x16x32_bf16 v[84:87], v[228:231], v[52:55], v[84:87]
    s_waitcnt lgkmcnt(5)
    v_mfma_f32_16x16x32_bf16 v[80:83], v[232:235], v[56:59], v[80:83]
    s_waitcnt lgkmcnt(4)
    v_mfma_f32_16x16x32_bf16 v[84:87], v[236:239], v[60:63], v[84:87]
    s_waitcnt lgkmcnt(3)
    v_mfma_f32_16x16x32_bf16 v[80:83], v[240:243], v[64:67], v[80:83]
    s_waitcnt lgkmcnt(2)
    v_mfma_f32_16x16x32_bf16 v[84:87], v[244:247], v[68:71], v[84:87]
    s_waitcnt lgkmcnt(1)
    v_mfma_f32_16x16x32_bf16 v[80:83], v[248:251], v[72:75], v[80:83]
    s_waitcnt lgkmcnt(0)
    v_mfma_f32_16x16x32_bf16 v[84:87], v[252:255], v[76:79], v[84:87]
    s_nop 7
    v_pk_add_f32 v[84:85], v[80:81], v[84:85]
    v_pk_add_f32 v[86:87], v[82:83], v[86:87]
    s_nop 0
    v_mov_b32_dpp v112, v84 quad_perm:[0,0,2,2] row_mask:0xf bank_mask:0xf
    v_mov_b32_dpp v116, v84 quad_perm:[1,1,3,3] row_mask:0xf bank_mask:0xf
    v_mov_b32_dpp v113, v85 quad_perm:[0,0,2,2] row_mask:0xf bank_mask:0xf
    v_mov_b32_dpp v117, v85 quad_perm:[1,1,3,3] row_mask:0xf bank_mask:0xf
    v_mov_b32_dpp v114, v86 quad_perm:[0,0,2,2] row_mask:0xf bank_mask:0xf
    v_mov_b32_dpp v118, v86 quad_perm:[1,1,3,3] row_mask:0xf bank_mask:0xf
    v_mov_b32_dpp v115, v87 quad_perm:[0,0,2,2] row_mask:0xf bank_mask:0xf
    v_mov_b32_dpp v119, v87 quad_perm:[1,1,3,3] row_mask:0xf bank_mask:0xf
    v_lshlrev_b32 v100, 16, v102
    v_and_b32 v101, 0xffff0000, v102
    v_lshlrev_b32 v102, 16, v103
    v_and_b32 v103, 0xffff0000, v103
    v_lshlrev_b32 v88, 16, v90
    v_and_b32 v89, 0xffff0000, v90
    v_lshlrev_b32 v90, 16, v91
    v_and_b32 v91, 0xffff0000, v91
    v_lshlrev_b32 v80, 16, v92
    v_and_b32 v81, 0xffff0000, v92
    v_lshlrev_b32 v82, 16, v93
    v_and_b32 v83, 0xffff0000, v93
    v_lshlrev_b32 v84, 16, v94
    v_and_b32 v85, 0xffff0000, v94
    v_lshlrev_b32 v86, 16, v95
    v_and_b32 v87, 0xffff0000, v95
    v_lshlrev_b32 v104, 16, v96
    v_and_b32 v105, 0xffff0000, v96
    v_lshlrev_b32 v106, 16, v97
    v_and_b32 v107, 0xffff0000, v97
    v_lshlrev_b32 v108, 16, v98
    v_and_b32 v109, 0xffff0000, v98
    v_lshlrev_b32 v110, 16, v99
    v_and_b32 v111, 0xffff0000, v99
    v_mov_b32 v1, s62
    v_mov_b32 v2, 0x3f803f80
    v_lshlrev_b32 v3, 3, v0
    v_mul_u32_u24 v4, 144, v8
    v_lshl_add_u32 v4, v7, 3, v4
    v_add_u32 v4, s34, v4
    s_setprio 3
    s_barrier
    ds_read_b128 v[16:19], v9 offset:0
    ds_read_b128 v[20:23], v9 offset:256
    ds_read_b128 v[24:27], v9 offset:32768
    ds_read_b128 v[28:31], v9 offset:33024
    ds_read_b128 v[32:35], v9 offset:2048
    ds_read_b128 v[36:39], v9 offset:2304
    ds_read_b128 v[40:43], v9 offset:34816
    ds_read_b128 v[44:47], v9 offset:35072
    s_waitcnt lgkmcnt(7)
    v_mfma_f32_16x16x32_bf16 v[64:67], v[128:131], v[16:19], 0
    ds_read_b128 v[48:51], v9 offset:8192
    s_waitcnt lgkmcnt(7)
    v_mfma_f32_16x16x32_bf16 v[68:71], v[128:131], v[20:23], 0
    ds_read_b128 v[52:55], v9 offset:8448
    s_waitcnt lgkmcnt(7)
    v_mfma_f32_16x16x32_bf16 v[72:75], v[128:131], v[24:27], 0
    ds_read_b128 v[56:59], v9 offset:40960
    s_waitcnt lgkmcnt(7)
    v_mfma_f32_16x16x32_bf16 v[76:79], v[128:131], v[28:31], 0
    ds_read_b128 v[60:63], v9 offset:41216
    s_waitcnt lgkmcnt(4)
    v_mfma_f32_16x16x32_bf16 v[64:67], v[132:135], v[32:35], v[64:67]
    ds_read_b128 v[16:19], v9 offset:10240
    v_mfma_f32_16x16x32_bf16 v[68:71], v[132:135], v[36:39], v[68:71]
    ds_read_b128 v[20:23], v9 offset:10496
    v_mfma_f32_16x16x32_bf16 v[72:75], v[132:135], v[40:43], v[72:75]
    ds_read_b128 v[24:27], v9 offset:43008
    v_mfma_f32_16x16x32_bf16 v[76:79], v[132:135], v[44:47], v[76:79]
    ds_read_b128 v[28:31], v9 offset:43264
    s_waitcnt lgkmcnt(4)
    v_mfma_f32_16x16x32_bf16 v[64:67], v[144:147], v[48:51], v[64:67]
    ds_read_b128 v[32:35], v9 offset:16384
    v_mfma_f32_16x16x32_bf16 v[68:71], v[144:147], v[52:55], v[68:71]
    ds_read_b128 v[36:39], v9 offset:16640
    v_mfma_f32_16x16x32_bf16 v[72:75], v[144:147], v[56:59], v[72:75]
    ds_read_b128 v[40:43], v9 offset:49152
    v_mfma_f32_16x16x32_bf16 v[76:79], v[144:147], v[60:63], v[76:79]
    ds_read_b128 v[44:47], v9 offset:49408
    s_waitcnt lgkmcnt(4)
    v_mfma_f32_16x16x32_bf16 v[64:67], v[148:151], v[16:19], v[64:67]
    ds_read_b128 v[48:51], v9 offset:18432
    v_mfma_f32_16x16x32_bf16 v[68:71], v[148:151], v[20:23], v[68:71]
    ds_read_b128 v[52:55], v9 offset:18688
    v_mfma_f32_16x16x32_bf16 v[72:75], v[148:151], v[24:27], v[72:75]
    ds_read_b128 v[56:59], v9 offset:51200
    v_mfma_f32_16x16x32_bf16 v[76:79], v[148:151], v[28:31], v[76:79]
    ds_read_b128 v[60:63], v9 offset:51456
    s_waitcnt lgkmcnt(4)
    v_mfma_f32_16x16x32_bf16 v[64:67], v[160:163], v[32:35], v[64:67]
    ds_read_b128 v[16:19], v9 offset:24576
    v_mfma_f32_16x16x32_bf16 v[68:71], v[160:163], v[36:39], v[68:71]
    ds_read_b128 v[20:23], v9 offset:24832
    v_mfma_f32_16x16x32_bf16 v[72:75], v[160:163], v[40:43], v[72:75]
    ds_read_b128 v[24:27], v9 offset:57344
    v_mfma_f32_16x16x32_bf16 v[76:79], v[160:163], v[44:47], v[76:79]
    ds_read_b128 v[28:31], v9 offset:57600
    s_waitcnt lgkmcnt(4)
    v_mfma_f32_16x16x32_bf16 v[64:67], v[164:167], v[48:51], v[64:67]
    ds_read_b128 v[32:35], v9 offset:26624
    v_mfma_f32_16x16x32_bf16 v[68:71], v[164:167], v[52:55], v[68:71]
    ds_read_b128 v[36:39], v9 offset:26880
    v_mfma_f32_16x16x32_bf16 v[72:75], v[164:167], v[56:59], v[72:75]
    ds_read_b128 v[40:43], v9 offset:59392
    v_mfma_f32_16x16x32_bf16 v[76:79], v[164:167], v[60:63], v[76:79]
    ds_read_b128 v[44:47], v9 offset:59648
    s_barrier
    s_waitcnt lgkmcnt(4)
    v_mfma_f32_16x16x32_bf16 v[64:67], v[176:179], v[16:19], v[64:67]
    ds_read_b128 v[48:51], v9 offset:4096
    v_mfma_f32_16x16x32_bf16 v[68:71], v[176:179], v[20:23], v[68:71]
    ds_read_b128 v[52:55], v9 offset:4352
    v_mfma_f32_16x16x32_bf16 v[72:75], v[176:179], v[24:27], v[72:75]
    ds_read_b128 v[56:59], v9 offset:36864
    v_mfma_f32_16x16x32_bf16 v[76:79], v[176:179], v[28:31], v[76:79]
    ds_read_b128 v[60:63], v9 offset:37120
    s_waitcnt lgkmcnt(4)
    v_mfma_f32_16x16x32_bf16 v[64:67], v[180:183], v[32:35], v[64:67]
    ds_read_b128 v[16:19], v9 offset:6144
    v_mfma_f32_16x16x32_bf16 v[68:71], v[180:183], v[36:39], v[68:71]
    ds_read_b128 v[20:23], v9 offset:6400
    v_mfma_f32_16x16x32_bf16 v[72:75], v[180:183], v[40:43], v[72:75]
    ds_read_b128 v[24:27], v9 offset:38912
    v_mfma_f32_16x16x32_bf16 v[76:79], v[180:183], v[44:47], v[76:79]
    ds_read_b128 v[28:31], v9 offset:39168
    s_waitcnt lgkmcnt(4)
    v_mfma_f32_16x16x32_bf16 v[64:67], v[136:139], v[48:51], v[64:67]
    ds_read_b128 v[32:35], v9 offset:12288
    v_mfma_f32_16x16x32_bf16 v[68:71], v[136:139], v[52:55], v[68:71]
    ds_read_b128 v[36:39], v9 offset:12544
    v_mfma_f32_16x16x32_bf16 v[72:75], v[136:139], v[56:59], v[72:75]
    ds_read_b128 v[40:43], v9 offset:45056
    v_mfma_f32_16x16x32_bf16 v[76:79], v[136:139], v[60:63], v[76:79]
    ds_read_b128 v[44:47], v9 offset:45312
    s_waitcnt lgkmcnt(4)
    v_mfma_f32_16x16x32_bf16 v[64:67], v[140:143], v[16:19], v[64:67]
    ds_read_b128 v[48:51], v9 offset:14336
    v_mfma_f32_16x16x32_bf16 v[68:71], v[140:143], v[20:23], v[68:71]
    ds_read_b128 v[52:55], v9 offset:14592
    v_mfma_f32_16x16x32_bf16 v[72:75], v[140:143], v[24:27], v[72:75]
    ds_read_b128 v[56:59], v9 offset:47104
    v_mfma_f32_16x16x32_bf16 v[76:79], v[140:143], v[28:31], v[76:79]
    ds_read_b128 v[60:63], v9 offset:47360
    s_waitcnt lgkmcnt(4)
    v_mfma_f32_16x16x32_bf16 v[64:67], v[152:155], v[32:35], v[64:67]
    ds_read_b128 v[16:19], v9 offset:20480
    v_mfma_f32_16x16x32_bf16 v[68:71], v[152:155], v[36:39], v[68:71]
    ds_read_b128 v[20:23], v9 offset:20736
    v_mfma_f32_16x16x32_bf16 v[72:75], v[152:155], v[40:43], v[72:75]
    ds_read_b128 v[24:27], v9 offset:53248
    v_mfma_f32_16x16x32_bf16 v[76:79], v[152:155], v[44:47], v[76:79]
    ds_read_b128 v[28:31], v9 offset:53504
    s_waitcnt lgkmcnt(4)
    v_mfma_f32_16x16x32_bf16 v[64:67], v[156:159], v[48:51], v[64:67]
    ds_read_b128 v[32:35], v9 offset:22528
    v_mfma_f32_16x16x32_bf16 v[68:71], v[156:159], v[52:55], v[68:71]
    ds_read_b128 v[36:39], v9 offset:22784
    v_mfma_f32_16x16x32_bf16 v[72:75], v[156:159], v[56:59], v[72:75]
    ds_read_b128 v[40:43], v9 offset:55296
    v_mfma_f32_16x16x32_bf16 v[76:79], v[156:159], v[60:63], v[76:79]
    ds_read_b128 v[44:47], v9 offset:55552
    s_waitcnt lgkmcnt(4)
    v_mfma_f32_16x16x32_bf16 v[64:67], v[168:171], v[16:19], v[64:67]
    ds_read_b128 v[48:51], v9 offset:28672
    v_mfma_f32_16x16x32_bf16 v[68:71], v[168:171], v[20:23], v[68:71]
    ds_read_b128 v[52:55], v9 offset:28928
    v_mfma_f32_16x16x32_bf16 v[72:75], v[168:171], v[24:27], v[72:75]
    ds_read_b128 v[56:59], v9 offset:61440
    v_mfma_f32_16x16x32_bf16 v[76:79], v[168:171], v[28:31], v[76:79]
    ds_read_b128 v[60:63], v9 offset:61696
    s_waitcnt lgkmcnt(4)
    v_mfma_f32_16x16x32_bf16 v[64:67], v[172:175], v[32:35], v[64:67]
    ds_read_b128 v[16:19], v9 offset:30720
    v_mfma_f32_16x16x32_bf16 v[68:71], v[172:175], v[36:39], v[68:71]
    ds_read_b128 v[20:23], v9 offset:30976
    v_mfma_f32_16x16x32_bf16 v[72:75], v[172:175], v[40:43], v[72:75]
    ds_read_b128 v[24:27], v9 offset:63488
    v_mfma_f32_16x16x32_bf16 v[76:79], v[172:175], v[44:47], v[76:79]
    ds_read_b128 v[28:31], v9 offset:63744
    s_waitcnt lgkmcnt(4)
    v_mfma_f32_16x16x32_bf16 v[64:67], v[184:187], v[48:51], v[64:67]
    v_mfma_f32_16x16x32_bf16 v[68:71], v[184:187], v[52:55], v[68:71]
    v_mfma_f32_16x16x32_bf16 v[72:75], v[184:187], v[56:59], v[72:75]
    v_mfma_f32_16x16x32_bf16 v[76:79], v[184:187], v[60:63], v[76:79]
    s_waitcnt lgkmcnt(0)
    v_mfma_f32_16x16x32_bf16 v[64:67], v[188:191], v[16:19], v[64:67]
    v_mfma_f32_16x16x32_bf16 v[68:71], v[188:191], v[20:23], v[68:71]
    v_mfma_f32_16x16x32_bf16 v[72:75], v[188:191], v[24:27], v[72:75]
    v_mfma_f32_16x16x32_bf16 v[76:79], v[188:191], v[28:31], v[76:79]
    s_nop 4
    v_pk_fma_f32 v[64:65], v[64:65], v[100:101], v[80:81]
    v_pk_fma_f32 v[66:67], v[66:67], v[102:103], v[82:83]
    v_pk_mul_f32 v[48:49], v[64:65], v[88:89]
    v_pk_mul_f32 v[50:51], v[66:67], v[90:91]
    v_cvt_pk_bf16_f32 v16, v48, v49
    v_cvt_pk_bf16_f32 v17, v50, v51
    v_pk_fma_f32 v[68:69], v[68:69], v[100:101], v[84:85]
    v_pk_fma_f32 v[70:71], v[70:71], v[102:103], v[86:87]
    v_pk_mul_f32 v[52:53], v[68:69], v[88:89]
    v_pk_mul_f32 v[54:55], v[70:71], v[90:91]
    v_cvt_pk_bf16_f32 v18, v52, v53
    v_cvt_pk_bf16_f32 v19, v54, v55
    v_pk_fma_f32 v[72:73], v[72:73], v[100:101], v[104:105]
    v_pk_fma_f32 v[74:75], v[74:75], v[102:103], v[106:107]
    v_pk_mul_f32 v[56:57], v[72:73], v[88:89]
    v_pk_mul_f32 v[58:59], v[74:75], v[90:91]
    v_cvt_pk_bf16_f32 v20, v56, v57
    v_cvt_pk_bf16_f32 v21, v58, v59
    v_permlane16_swap_b32 v16, v18
    v_permlane16_swap_b32 v17, v19
    v_pk_fma_f32 v[76:77], v[76:77], v[100:101], v[108:109]
    v_pk_fma_f32 v[78:79], v[78:79], v[102:103], v[110:111]
    v_pk_mul_f32 v[60:61], v[76:77], v[88:89]
    v_pk_mul_f32 v[62:63], v[78:79], v[90:91]
    v_cvt_pk_bf16_f32 v22, v60, v61
    v_cvt_pk_bf16_f32 v23, v62, v63
    s_cmp_eq_u32 s66, 0
    s_cbranch_scc1 L_safe_67
    buffer_store_dwordx4 v[16:19], v6, s[44:47], s9 offen nt
    v_permlane16_swap_b32 v20, v22
    v_permlane16_swap_b32 v21, v23
    buffer_store_dwordx4 v[20:23], v6, s[44:47], s10 offen nt
    v_cvt_pk_bf16_f32 v24, v64, v65
    v_cvt_pk_bf16_f32 v25, v66, v67
    v_cvt_pk_bf16_f32 v26, v68, v69
    v_cvt_pk_bf16_f32 v27, v70, v71
    v_cvt_pk_bf16_f32 v28, v72, v73
    v_cvt_pk_bf16_f32 v29, v74, v75
    v_cvt_pk_bf16_f32 v30, v76, v77
    v_cvt_pk_bf16_f32 v31, v78, v79
    v_dot2_f32_bf16 v40, v24, v2, 0
    v_dot2_f32_bf16 v41, v24, v24, 0
    v_dot2_f32_bf16 v42, v26, v2, 0
    v_dot2_f32_bf16 v43, v26, v26, 0
    v_dot2_f32_bf16 v44, v28, v2, 0
    v_dot2_f32_bf16 v45, v28, v28, 0
    v_dot2_f32_bf16 v46, v30, v2, 0
    v_dot2_f32_bf16 v47, v30, v30, 0
    v_dot2_f32_bf16 v40, v25, v2, v40
    v_dot2_f32_bf16 v41, v25, v25, v41
    v_dot2_f32_bf16 v42, v27, v2, v42
    v_dot2_f32_bf16 v43, v27, v27, v43
    v_dot2_f32_bf16 v44, v29, v2, v44
    v_dot2_f32_bf16 v45, v29, v29, v45
    v_dot2_f32_bf16 v46, v31, v2, v46
    v_dot2_f32_bf16 v47, v31, v31, v47
    ds_write_b64 v4, v[24:25] offset:0
    ds_write_b64 v4, v[26:27] offset:2304
    ds_write_b64 v4, v[28:29] offset:4608
    ds_write_b64 v4, v[30:31] offset:6912
    v_permlane32_swap_b32 v40, v44
    v_permlane32_swap_b32 v41, v45
    v_permlane32_swap_b32 v42, v46
    v_permlane32_swap_b32 v43, v47
    v_pk_add_f32 v[40:41], v[40:41], v[44:45]
    v_pk_add_f32 v[42:43], v[42:43], v[46:47]
    s_nop 1
    v_permlane16_swap_b32 v40, v42
    v_permlane16_swap_b32 v41, v43
    v_pk_add_f32 v[40:41], v[40:41], v[42:43]
    buffer_store_dwordx2 v[40:41], v3, s[44:47], s11 offen nt
    s_waitcnt vmcnt(1)
    s_mov_b64 exec, 1
    buffer_store_dword v1, v6, s[44:47], s12 offen nt
    s_mov_b64 exec, -1
    s_barrier
    s_waitcnt vmcnt(1)
    s_add_u32 s12, s12, 128
    s_mov_b64 exec, 1
    buffer_store_dword v1, v6, s[44:47], s12 offen nt
    s_mov_b64 exec, -1
L_pubd_68:
    v_and_b32 v1, 7, v0
    v_lshlrev_b32 v1, 2, v1
    s_mov_b32 s67, 0x40000
L_poll_69:
    buffer_load_dword v2, v1, s[44:47], s13 offen sc1
    s_sub_u32 s67, s67, 1
    s_cbranch_scc1 L_polld_70
    s_waitcnt vmcnt(0)
    v_cmp_ne_u32 vcc, s62, v2
    s_nop 0
    s_cbranch_vccnz L_poll_69
L_polld_70:
    s_waitcnt vmcnt(0)
    s_branch L_noC
L_cA:
    s_mov_b32 s67, 0x40000
L_poll_71:
    buffer_load_dword v2, v1, s[44:47], s6 offen sc1
    s_sub_u32 s67, s67, 1
    s_cbranch_scc1 L_polld_72
    s_waitcnt vmcnt(0)
    v_cmp_ne_u32 vcc, s62, v2
    s_nop 0
    s_cbranch_vccnz L_poll_71
L_polld_72:
    s_waitcnt vmcnt(0)
    s_add_u32 s76, s7, 0
    s_add_u32 m0, s8, 65536
    s_nop 0
    buffer_load_dwordx4 v6, s[44:47], s76 offen sc1 lds
    buffer_load_dwordx4 v6, s[44:47], s76 offen offset:1024 sc1 lds
    buffer_load_dwordx4 v6, s[44:47], s76 offen offset:2048 sc1 lds
    buffer_load_dwordx4 v6, s[44:47], s76 offen offset:3072 sc1 lds
    s_add_u32 s76, s7, 32768
    s_add_u32 m0, s8, 98304
    s_nop 0
    buffer_load_dwordx4 v6, s[44:47], s76 offen sc1 lds
    buffer_load_dwordx4 v6, s[44:47], s76 offen offset:1024 sc1 lds
    buffer_load_dwordx4 v6, s[44:47], s76 offen offset:2048 sc1 lds
    buffer_load_dwordx4 v6, s[44:47], s76 offen offset:3072 sc1 lds
    s_add_u32 s76, s7, 4096
    s_add_u32 m0, s8, 69632
    s_nop 0
    buffer_load_dwordx4 v6, s[44:47], s76 offen sc1 lds
    buffer_load_dwordx4 v6, s[44:47], s76 offen offset:1024 sc1 lds
    buffer_load_dwordx4 v6, s[44:47], s76 offen offset:2048 sc1 lds
    buffer_load_dwordx4 v6, s[44:47], s76 offen offset:3072 sc1 lds
    s_waitcnt vmcnt(4)
    s_barrier
    s_add_u32 s76, s7, 36864
    s_add_u32 m0, s8, 102400
    s_nop 0
    buffer_load_dwordx4 v6, s[44:47], s76 offen sc1 lds
    buffer_load_dwordx4 v6, s[44:47], s76 offen offset:1024 sc1 lds
    buffer_load_dwordx4 v6, s[44:47], s76 offen offset:2048 sc1 lds
    buffer_load_dwordx4 v6, s[44:47], s76 offen offset:3072 sc1 lds
    s_add_u32 s76, s75, 0
    s_add_u32 m0, s36, 0
    s_nop 0
    buffer_load_dwordx4 v6, s[44:47], s76 offen sc1 lds
    buffer_load_dwordx4 v6, s[44:47], s76 offen offset:1024 sc1 lds
    buffer_load_dwordx4 v6, s[44:47], s76 offen offset:2048 sc1 lds
    buffer_load_dwordx4 v6, s[44:47], s76 offen offset:3072 sc1 lds
    s_waitcnt vmcnt(4)
    s_barrier
    s_add_u32 s76, s75, 4096
    s_add_u32 m0, s36, 4096
    s_nop 0
    buffer_load_dwordx4 v6, s[44:47], s76 offen sc1 lds
    buffer_load_dwordx4 v6, s[44:47], s76 offen offset:1024 sc1 lds
    buffer_load_dwordx4 v6, s[44:47], s76 offen offset:2048 sc1 lds
    buffer_load_dwordx4 v6, s[44:47], s76 offen offset:3072 sc1 lds
    s_add_u32 s76, s75, 8192
    s_add_u32 m0, s36, 8192
    s_nop 0
    buffer_load_dwordx4 v6, s[44:47], s76 offen sc1 lds
    buffer_load_dwordx4 v6, s[44:47], s76 offen offset:1024 sc1 lds
    buffer_load_dwordx4 v6, s[44:47], s76 offen offset:2048 sc1 lds
    buffer_load_dwordx4 v6, s[44:47], s76 offen offset:3072 sc1 lds
    s_add_u32 s76, s75, 12288
    s_add_u32 m0, s36, 12288
    s_nop 0
    buffer_load_dwordx4 v6, s[44:47], s76 offen sc1 lds
    buffer_load_dwordx4 v6, s[44:47], s76 offen offset:1024 sc1 lds
    buffer_load_dwordx4 v6, s[44:47], s76 offen offset:2048 sc1 lds
    buffer_load_dwordx4 v6, s[44:47], s76 offen offset:3072 sc1 lds
    v_and_b32 v1, 7, v0
    v_lshlrev_b32 v1, 2, v1
    v_lshlrev_b32 v3, 3, v0
    ds_read_b128 v[16:19], v11 offset:0
    ds_read_b128 v[20:23], v11 offset:64
    ds_read_b128 v[24:27], v11 offset:128
    ds_read_b128 v[28:31], v11 offset:192
    ds_read_b128 v[32:35], v11 offset:256
    ds_read_b128 v[36:39], v11 offset:320
    ds_read_b128 v[40:43], v11 offset:384
    ds_read_b128 v[44:47], v11 offset:448
    ds_read_b128 v[48:51], v11 offset:512
    ds_read_b128 v[52:55], v11 offset:576
    ds_read_b128 v[56:59], v11 offset:640
    ds_read_b128 v[60:63], v11 offset:704
    ds_read_b128 v[64:67], v11 offset:768
    ds_read_b128 v[68:71], v11 offset:832
    ds_read_b128 v[72:75], v11 offset:896
    ds_read_b128 v[76:79], v11 offset:960
    s_waitcnt lgkmcnt(0)
    s_barrier
    s_mov_b32 s67, 0x40000
L_poll_73:
    buffer_load_dword v2, v1, s[44:47], s13 offen sc1
    s_sub_u32 s67, s67, 1
    s_cbranch_scc1 L_polld_74
    s_waitcnt vmcnt(0)
    v_cmp_ne_u32 vcc, s62, v2
    s_nop 0
    s_cbranch_vccnz L_poll_73
L_polld_74:
    s_waitcnt vmcnt(0)
    s_add_u32 s76, s7, 262144
    s_add_u32 m0, s8, 65536
    s_nop 0
    buffer_load_dwordx4 v6, s[44:47], s76 offen sc1 lds
    v_mfma_f32_16x16x32_bf16 v[80:83], v[128:131], v[16:19], 0
    v_mfma_f32_16x16x32_bf16 v[84:87], v[192:195], v[16:19], 0
    v_mfma_f32_16x16x32_bf16 v[80:83], v[132:135], v[20:23], v[80:83]
    v_mfma_f32_16x16x32_bf16 v[84:87], v[196:199], v[20:23], v[84:87]
    buffer_load_dwordx4 v6, s[44:47], s76 offen offset:1024 sc1 lds
    v_mfma_f32_16x16x32_bf16 v[80:83], v[136:139], v[24:27], v[80:83]
    v_mfma_f32_16x16x32_bf16 v[84:87], v[200:203], v[24:27], v[84:87]
    v_mfma_f32_16x16x32_bf16 v[80:83], v[140:143], v[28:31], v[80:83]
    v_mfma_f32_16x16x32_bf16 v[84:87], v[204:207], v[28:31], v[84:87]
    buffer_load_dwordx4 v6, s[44:47], s76 offen offset:2048 sc1 lds
    v_mfma_f32_16x16x32_bf16 v[80:83], v[144:147], v[32:35], v[80:83]
    v_mfma_f32_16x16x32_bf16 v[84:87], v[208:211], v[32:35], v[84:87]
    v_mfma_f32_16x16x32_bf16 v[80:83], v[148:151], v[36:39], v[80:83]
    v_mfma_f32_16x16x32_bf16 v[84:87], v[212:215], v[36:39], v[84:87]
    buffer_load_dwordx4 v6, s[44:47], s76 offen offset:3072 sc1 lds
    v_mfma_f32_16x16x32_bf16 v[80:83], v[152:155], v[40:43], v[80:83]
    v_mfma_f32_16x16x32_bf16 v[84:87], v[216:219], v[40:43], v[84:87]
    v_mfma_f32_16x16x32_bf16 v[80:83], v[156:159], v[44:47], v[80:83]
    v_mfma_f32_16x16x32_bf16 v[84:87], v[220:223], v[44:47], v[84:87]
    s_add_u32 s76, s7, 294912
    s_add_u32 m0, s8, 98304
    s_nop 0
    buffer_load_dwordx4 v6, s[44:47], s76 offen sc1 lds
    v_mfma_f32_16x16x32_bf16 v[80:83], v[160:163], v[48:51], v[80:83]
    v_mfma_f32_16x16x32_bf16 v[84:87], v[224:227], v[48:51], v[84:87]
    v_mfma_f32_16x16x32_bf16 v[80:83], v[164:167], v[52:55], v[80:83]
    v_mfma_f32_16x16x32_bf16 v[84:87], v[228:231], v[52:55], v[84:87]
    buffer_load_dwordx4 v6, s[44:47], s76 offen offset:1024 sc1 lds
    v_mfma_f32_16x16x32_bf16 v[80:83], v[168:171], v[56:59], v[80:83]
    v_mfma_f32_16x16x32_bf16 v[84:87], v[232:235], v[56:59], v[84:87]
    v_mfma_f32_16x16x32_bf16 v[80:83], v[172:175], v[60:63], v[80:83]
    v_mfma_f32_16x16x32_bf16 v[84:87], v[236:239], v[60:63], v[84:87]
    buffer_load_dwordx4 v6, s[44:47], s76 offen offset:2048 sc1 lds
    v_mfma_f32_16x16x32_bf16 v[80:83], v[176:179], v[64:67], v[80:83]
    v_mfma_f32_16x16x32_bf16 v[84:87], v[240:243], v[64:67], v[84:87]
    v_mfma_f32_16x16x32_bf16 v[80:83], v[180:183], v[68:71], v[80:83]
    v_mfma_f32_16x16x32_bf16 v[84:87], v[244:247], v[68:71], v[84:87]
    buffer_load_dwordx4 v6, s[44:47], s76 offen offset:3072 sc1 lds
    v_mfma_f32_16x16x32_bf16 v[80:83], v[184:187], v[72:75], v[80:83]
    v_mfma_f32_16x16x32_bf16 v[84:87], v[248:251], v[72:75], v[84:87]
    v_mfma_f32_16x16x32_bf16 v[80:83], v[188:191], v[76:79], v[80:83]
    v_mfma_f32_16x16x32_bf16 v[84:87], v[252:255], v[76:79], v[84:87]
    s_add_u32 s76, s7, 266240
    s_add_u32 m0, s8, 69632
    s_nop 0
    buffer_load_dwordx4 v6, s[44:47], s76 offen sc1 lds
    buffer_load_dwordx4 v6, s[44:47], s76 offen offset:1024 sc1 lds
    buffer_load_dwordx4 v6, s[44:47], s76 offen offset:2048 sc1 lds
    buffer_load_dwordx4 v6, s[44:47], s76 offen offset:3072 sc1 lds
    v_mov_b32_dpp v104, v80 quad_perm:[0,0,2,2] row_mask:0xf bank_mask:0xf
    v_mov_b32_dpp v108, v80 quad_perm:[1,1,3,3] row_mask:0xf bank_mask:0xf
    v_mov_b32_dpp v105, v81 quad_perm:[0,0,2,2] row_mask:0xf bank_mask:0xf
    v_mov_b32_dpp v109, v81 quad_perm:[1,1,3,3] row_mask:0xf bank_mask:0xf
    v_mov_b32_dpp v106, v82 quad_perm:[0,0,2,2] row_mask:0xf bank_mask:0xf
    v_mov_b32_dpp v110, v82 quad_perm:[1,1,3,3] row_mask:0xf bank_mask:0xf
    v_mov_b32_dpp v107, v83 quad_perm:[0,0,2,2] row_mask:0xf bank_mask:0xf
    v_mov_b32_dpp v111, v83 quad_perm:[1,1,3,3] row_mask:0xf bank_mask:0xf
    v_mov_b32_dpp v112, v84 quad_perm:[0,0,2,2] row_mask:0xf bank_mask:0xf
    v_mov_b32_dpp v116, v84 quad_perm:[1,1,3,3] row_mask:0xf bank_mask:0xf
    v_mov_b32_dpp v113, v85 quad_perm:[0,0,2,2] row_mask:0xf bank_mask:0xf
    v_mov_b32_dpp v117, v85 quad_perm:[1,1,3,3] row_mask:0xf bank_mask:0xf
    v_mov_b32_dpp v114, v86 quad_perm:[0,0,2,2] row_mask:0xf bank_mask:0xf
    v_mov_b32_dpp v118, v86 quad_perm:[1,1,3,3] row_mask:0xf bank_mask:0xf
    v_mov_b32_dpp v115, v87 quad_perm:[0,0,2,2] row_mask:0xf bank_mask:0xf
    v_mov_b32_dpp v119, v87 quad_perm:[1,1,3,3] row_mask:0xf bank_mask:0xf
L_noC:
    s_lshl_b32 s76, s3, 9
    s_lshl1_add_u32 s77, s76, 148736
    v_add_u32 v1, s77, v6
    s_add_u32 s77, s76, 156928
    v_add_u32 v5, s77, v3
    v_lshl_add_u32 v4, v8, 3, s77
    v_add_u32 v11, 152832, v3
    v_mul_u32_u24 v2, 144, v7
    s_mul_i32 s76, s3, 576
    s_add_u32 s76, s76, 132096
    v_lshl_add_u32 v2, v8, 3, v2
    v_add_u32 v124, s76, v2
    v_lshlrev_b32 v125, 3, v8
    v_add_u32 v125, 150016, v125
    s_waitcnt vmcnt(4)
    s_waitcnt lgkmcnt(0)
    s_barrier
    s_cmp_ge_u32 s3, 4
    s_cbranch_scc1 L_dB
    s_setprio 0
    ds_read_b128 v[16:19], v9 offset:0
    ds_read_b128 v[20:23], v9 offset:256
    ds_read_b128 v[24:27], v9 offset:32768
    ds_read_b128 v[28:31], v9 offset:33024
    ds_read_b128 v[32:35], v9 offset:2048
    ds_read_b128 v[36:39], v9 offset:2304
    ds_read_b128 v[40:43], v9 offset:34816
    ds_read_b128 v[44:47], v9 offset:35072
    s_waitcnt lgkmcnt(7)
    v_mfma_f32_16x16x32_bf16 v[64:67], v[128:131], v[16:19], 0
    v_mfma_f32_16x16x32_bf16 v[80:83], v[192:195], v[16:19], 0
    ds_read_b128 v[48:51], v9 offset:8192
    s_waitcnt lgkmcnt(7)
    v_mfma_f32_16x16x32_bf16 v[68:71], v[128:131], v[20:23], 0
    v_mfma_f32_16x16x32_bf16 v[84:87], v[192:195], v[20:23], 0
    ds_read_b128 v[52:55], v9 offset:8448
    s_waitcnt lgkmcnt(7)
    v_mfma_f32_16x16x32_bf16 v[72:75], v[128:131], v[24:27], 0
    v_mfma_f32_16x16x32_bf16 v[88:91], v[192:195], v[24:27], 0
    ds_read_b128 v[56:59], v9 offset:40960
    s_waitcnt lgkmcnt(7)
    v_mfma_f32_16x16x32_bf16 v[76:79], v[128:131], v[28:31], 0
    v_mfma_f32_16x16x32_bf16 v[92:95], v[192:195], v[28:31], 0
    ds_read_b128 v[60:63], v9 offset:41216
    s_waitcnt lgkmcnt(4)
    v_mfma_f32_16x16x32_bf16 v[64:67], v[132:135], v[32:35], v[64:67]
    v_mfma_f32_16x16x32_bf16 v[80:83], v[196:199], v[32:35], v[80:83]
    ds_read_b128 v[16:19], v9 offset:10240
    v_mfma_f32_16x16x32_bf16 v[68:71], v[132:135], v[36:39], v[68:71]
    v_mfma_f32_16x16x32_bf16 v[84:87], v[196:199], v[36:39], v[84:87]
    ds_read_b128 v[20:23], v9 offset:10496
    v_mfma_f32_16x16x32_bf16 v[72:75], v[132:135], v[40:43], v[72:75]
    v_mfma_f32_16x16x32_bf16 v[88:91], v[196:199], v[40:43], v[88:91]
    ds_read_b128 v[24:27], v9 offset:43008
    v_mfma_f32_16x16x32_bf16 v[76:79], v[132:135], v[44:47], v[76:79]
    v_mfma_f32_16x16x32_bf16 v[92:95], v[196:199], v[44:47], v[92:95]
    ds_read_b128 v[28:31], v9 offset:43264
    ds_read_b128 v[128:131], v10 offset:0
    s_waitcnt lgkmcnt(5)
    v_mfma_f32_16x16x32_bf16 v[64:67], v[144:147], v[48:51], v[64:67]
    v_mfma_f32_16x16x32_bf16 v[80:83], v[208:211], v[48:51], v[80:83]
    ds_read_b128 v[32:35], v9 offset:16384
    v_mfma_f32_16x16x32_bf16 v[68:71], v[144:147], v[52:55], v[68:71]
    v_mfma_f32_16x16x32_bf16 v[84:87], v[208:211], v[52:55], v[84:87]
    ds_read_b128 v[36:39], v9 offset:16640
    ds_read_b128 v[192:195], v10 offset:1024
    v_mfma_f32_16x16x32_bf16 v[72:75], v[144:147], v[56:59], v[72:75]
    v_mfma_f32_16x16x32_bf16 v[88:91], v[208:211], v[56:59], v[88:91]
    ds_read_b128 v[40:43], v9 offset:49152
    v_mfma_f32_16x16x32_bf16 v[76:79], v[144:147], v[60:63], v[76:79]
    v_mfma_f32_16x16x32_bf16 v[92:95], v[208:211], v[60:63], v[92:95]
    ds_read_b128 v[44:47], v9 offset:49408
    ds_read_b128 v[132:135], v10 offset:2048
    s_waitcnt lgkmcnt(7)
    v_mfma_f32_16x16x32_bf16 v[64:67], v[148:151], v[16:19], v[64:67]
    v_mfma_f32_16x16x32_bf16 v[80:83], v[212:215], v[16:19], v[80:83]
    ds_read_b128 v[48:51], v9 offset:18432
    v_mfma_f32_16x16x32_bf16 v[68:71], v[148:151], v[20:23], v[68:71]
    v_mfma_f32_16x16x32_bf16 v[84:87], v[212:215], v[20:23], v[84:87]
    ds_read_b128 v[52:55], v9 offset:18688
    ds_read_b128 v[196:199], v10 offset:3072
    v_mfma_f32_16x16x32_bf16 v[72:75], v[148:151], v[24:27], v[72:75]
    v_mfma_f32_16x16x32_bf16 v[88:91], v[212:215], v[24:27], v[88:91]
    ds_read_b128 v[56:59], v9 offset:51200
    v_mfma_f32_16x16x32_bf16 v[76:79], v[148:151], v[28:31], v[76:79]
    v_mfma_f32_16x16x32_bf16 v[92:95], v[212:215], v[28:31], v[92:95]
    ds_read_b128 v[60:63], v9 offset:51456
    ds_read_b128 v[144:147], v10 offset:4096
    s_waitcnt lgkmcnt(7)
    v_mfma_f32_16x16x32_bf16 v[64:67], v[160:163], v[32:35], v[64:67]
    v_mfma_f32_16x16x32_bf16 v[80:83], v[224:227], v[32:35], v[80:83]
    ds_read_b128 v[16:19], v9 offset:24576
    v_mfma_f32_16x16x32_bf16 v[68:71], v[160:163], v[36:39], v[68:71]
    v_mfma_f32_16x16x32_bf16 v[84:87], v[224:227], v[36:39], v[84:87]
    ds_read_b128 v[20:23], v9 offset:24832
    ds_read_b128 v[208:211], v10 offset:5120
    v_mfma_f32_16x16x32_bf16 v[72:75], v[160:163], v[40:43], v[72:75]
    v_mfma_f32_16x16x32_bf16 v[88:91], v[224:227], v[40:43], v[88:91]
    ds_read_b128 v[24:27], v9 offset:57344
    v_mfma_f32_16x16x32_bf16 v[76:79], v[160:163], v[44:47], v[76:79]
    v_mfma_f32_16x16x32_bf16 v[92:95], v[224:227], v[44:47], v[92:95]
    ds_read_b128 v[28:31], v9 offset:57600
    ds_read_b128 v[148:151], v10 offset:6144
    s_waitcnt lgkmcnt(7)
    v_mfma_f32_16x16x32_bf16 v[64:67], v[164:167], v[48:51], v[64:67]
    v_mfma_f32_16x16x32_bf16 v[80:83], v[228:231], v[48:51], v[80:83]
    ds_read_b128 v[32:35], v9 offset:26624
    v_mfma_f32_16x16x32_bf16 v[68:71], v[164:167], v[52:55], v[68:71]
    v_mfma_f32_16x16x32_bf16 v[84:87], v[228:231], v[52:55], v[84:87]
    ds_read_b128 v[36:39], v9 offset:26880
    ds_read_b128 v[212:215], v10 offset:7168
    v_mfma_f32_16x16x32_bf16 v[72:75], v[164:167], v[56:59], v[72:75]
    v_mfma_f32_16x16x32_bf16 v[88:91], v[228:231], v[56:59], v[88:91]
    ds_read_b128 v[40:43], v9 offset:59392
    v_mfma_f32_16x16x32_bf16 v[76:79], v[164:167], v[60:63], v[76:79]
    v_mfma_f32_16x16x32_bf16 v[92:95], v[228:231], v[60:63], v[92:95]
    ds_read_b128 v[44:47], v9 offset:59648
    ds_read_b128 v[160:163], v10 offset:8192
    s_waitcnt vmcnt(0)
    s_barrier
    s_waitcnt lgkmcnt(7)
    v_mfma_f32_16x16x32_bf16 v[64:67], v[176:179], v[16:19], v[64:67]
    v_mfma_f32_16x16x32_bf16 v[80:83], v[240:243], v[16:19], v[80:83]
    ds_read_b128 v[48:51], v9 offset:4096
    v_mfma_f32_16x16x32_bf16 v[68:71], v[176:179], v[20:23], v[68:71]
    v_mfma_f32_16x16x32_bf16 v[84:87], v[240:243], v[20:23], v[84:87]
    ds_read_b128 v[52:55], v9 offset:4352
    ds_read_b128 v[224:227], v10 offset:9216
    v_mfma_f32_16x16x32_bf16 v[72:75], v[176:179], v[24:27], v[72:75]
    v_mfma_f32_16x16x32_bf16 v[88:91], v[240:243], v[24:27], v[88:91]
    ds_read_b128 v[56:59], v9 offset:36864
    v_mfma_f32_16x16x32_bf16 v[76:79], v[176:179], v[28:31], v[76:79]
    v_mfma_f32_16x16x32_bf16 v[92:95], v[240:243], v[28:31], v[92:95]
    ds_read_b128 v[60:63], v9 offset:37120
    ds_read_b128 v[164:167], v10 offset:10240
    s_waitcnt lgkmcnt(7)
    v_mfma_f32_16x16x32_bf16 v[64:67], v[180:183], v[32:35], v[64:67]
    v_mfma_f32_16x16x32_bf16 v[80:83], v[244:247], v[32:35], v[80:83]
    ds_read_b128 v[16:19], v9 offset:6144
    v_mfma_f32_16x16x32_bf16 v[68:71], v[180:183], v[36:39], v[68:71]
    v_mfma_f32_16x16x32_bf16 v[84:87], v[244:247], v[36:39], v[84:87]
    ds_read_b128 v[20:23], v9 offset:6400
    ds_read_b128 v[228:231], v10 offset:11264
    v_mfma_f32_16x16x32_bf16 v[72:75], v[180:183], v[40:43], v[72:75]
    v_mfma_f32_16x16x32_bf16 v[88:91], v[244:247], v[40:43], v[88:91]
    ds_read_b128 v[24:27], v9 offset:38912
    v_mfma_f32_16x16x32_bf16 v[76:79], v[180:183], v[44:47], v[76:79]
    v_mfma_f32_16x16x32_bf16 v[92:95], v[244:247], v[44:47], v[92:95]
    ds_read_b128 v[28:31], v9 offset:39168
    ds_read_b128 v[176:179], v10 offset:12288
    ds_read_b64 v[96:97], v11 offset:0
    ds_read_b64 v[98:99], v11 offset:512
    ds_read_b64 v[100:101], v11 offset:1024
    ds_read_b64 v[102:103], v11 offset:1536
    s_waitcnt lgkmcnt(11)
    v_mfma_f32_16x16x32_bf16 v[64:67], v[136:139], v[48:51], v[64:67]
    v_mfma_f32_16x16x32_bf16 v[80:83], v[200:203], v[48:51], v[80:83]
    ds_read_b128 v[32:35], v9 offset:12288
    v_mfma_f32_16x16x32_bf16 v[68:71], v[136:139], v[52:55], v[68:71]
    v_mfma_f32_16x16x32_bf16 v[84:87], v[200:203], v[52:55], v[84:87]
    ds_read_b128 v[36:39], v9 offset:12544
    ds_read_b128 v[240:243], v10 offset:13312
    v_mfma_f32_16x16x32_bf16 v[72:75], v[136:139], v[56:59], v[72:75]
    v_mfma_f32_16x16x32_bf16 v[88:91], v[200:203], v[56:59], v[88:91]
    ds_read_b128 v[40:43], v9 offset:45056
    v_mfma_f32_16x16x32_bf16 v[76:79], v[136:139], v[60:63], v[76:79]
    v_mfma_f32_16x16x32_bf16 v[92:95], v[200:203], v[60:63], v[92:95]
    ds_read_b128 v[44:47], v9 offset:45312
    ds_read_b128 v[180:183], v10 offset:14336
    s_waitcnt lgkmcnt(11)
    v_mfma_f32_16x16x32_bf16 v[64:67], v[140:143], v[16:19], v[64:67]
    v_mfma_f32_16x16x32_bf16 v[80:83], v[204:207], v[16:19], v[80:83]
    ds_read_b128 v[48:51], v9 offset:14336
    v_mfma_f32_16x16x32_bf16 v[68:71], v[140:143], v[20:23], v[68:71]
    v_mfma_f32_16x16x32_bf16 v[84:87], v[204:207], v[20:23], v[84:87]
    ds_read_b128 v[52:55], v9 offset:14592
    ds_read_b128 v[244:247], v10 offset:15360
    v_mfma_f32_16x16x32_bf16 v[72:75], v[140:143], v[24:27], v[72:75]
    v_mfma_f32_16x16x32_bf16 v[88:91], v[204:207], v[24:27], v[88:91]
    ds_read_b128 v[56:59], v9 offset:47104
    v_mfma_f32_16x16x32_bf16 v[76:79], v[140:143], v[28:31], v[76:79]
    v_mfma_f32_16x16x32_bf16 v[92:95], v[204:207], v[28:31], v[92:95]
    ds_read_b128 v[60:63], v9 offset:47360
    s_add_u32 s78, s75, 16384
    buffer_load_dwordx4 v[136:139], v6, s[44:47], s78 offen offset:0 sc1
    s_waitcnt lgkmcnt(13)
    v_add_f32 v96, v96, v98
    v_add_f32 v97, v97, v99
    s_waitcnt lgkmcnt(11)
    v_add_f32 v100, v100, v102
    v_add_f32 v101, v101, v103
    v_add_f32 v12, v96, v100
    v_add_f32 v13, v97, v101
    ds_read_b64 v[96:97], v11 offset:2048
    ds_read_b64 v[98:99], v11 offset:2560
    ds_read_b64 v[100:101], v11 offset:3072
    ds_read_b64 v[102:103], v11 offset:3584
    s_waitcnt lgkmcnt(10)
    v_mfma_f32_16x16x32_bf16 v[64:67], v[152:155], v[32:35], v[64:67]
    v_mfma_f32_16x16x32_bf16 v[80:83], v[216:219], v[32:35], v[80:83]
    ds_read_b128 v[16:19], v9 offset:20480
    v_mfma_f32_16x16x32_bf16 v[68:71], v[152:155], v[36:39], v[68:71]
    v_mfma_f32_16x16x32_bf16 v[84:87], v[216:219], v[36:39], v[84:87]
    ds_read_b128 v[20:23], v9 offset:20736
    s_add_u32 s79, s75, 16384
    buffer_load_dwordx4 v[200:203], v6, s[44:47], s79 offen offset:1024 sc1
    v_mfma_f32_16x16x32_bf16 v[72:75], v[152:155], v[40:43], v[72:75]
    v_mfma_f32_16x16x32_bf16 v[88:91], v[216:219], v[40:43], v[88:91]
    ds_read_b128 v[24:27], v9 offset:53248
    v_mfma_f32_16x16x32_bf16 v[76:79], v[152:155], v[44:47], v[76:79]
    v_mfma_f32_16x16x32_bf16 v[92:95], v[216:219], v[44:47], v[92:95]
    ds_read_b128 v[28:31], v9 offset:53504
    buffer_load_dwordx4 v[140:143], v6, s[44:47], s78 offen offset:2048 sc1
    s_waitcnt lgkmcnt(8)
    v_mfma_f32_16x16x32_bf16 v[64:67], v[156:159], v[48:51], v[64:67]
    v_mfma_f32_16x16x32_bf16 v[80:83], v[220:223], v[48:51], v[80:83]
    ds_read_b128 v[32:35], v9 offset:22528
    v_mfma_f32_16x16x32_bf16 v[68:71], v[156:159], v[52:55], v[68:71]
    v_mfma_f32_16x16x32_bf16 v[84:87], v[220:223], v[52:55], v[84:87]
    ds_read_b128 v[36:39], v9 offset:22784
    buffer_load_dwordx4 v[204:207], v6, s[44:47], s79 offen offset:3072 sc1
    v_mfma_f32_16x16x32_bf16 v[72:75], v[156:159], v[56:59], v[72:75]
    v_mfma_f32_16x16x32_bf16 v[88:91], v[220:223], v[56:59], v[88:91]
    ds_read_b128 v[40:43], v9 offset:55296
    v_mfma_f32_16x16x32_bf16 v[76:79], v[156:159], v[60:63], v[76:79]
    v_mfma_f32_16x16x32_bf16 v[92:95], v[220:223], v[60:63], v[92:95]
    ds_read_b128 v[44:47], v9 offset:55552
    s_add_u32 s78, s75, 20480
    buffer_load_dwordx4 v[152:155], v6, s[44:47], s78 offen offset:0 sc1
    s_waitcnt lgkmcnt(10)
    v_add_f32 v96, v96, v98
    v_add_f32 v97, v97, v99
    s_waitcnt lgkmcnt(8)
    v_add_f32 v100, v100, v102
    v_add_f32 v101, v101, v103
    v_add_f32 v12, v12, v96
    v_add_f32 v13, v13, v97
    v_add_f32 v12, v12, v100
    v_add_f32 v13, v13, v101
    v_mul_f32 v12, 0x3b000000, v12
    v_mul_f32 v13, 0x3b000000, v13
    s_waitcnt lgkmcnt(4)
    v_mfma_f32_16x16x32_bf16 v[64:67], v[168:171], v[16:19], v[64:67]
    v_mfma_f32_16x16x32_bf16 v[80:83], v[232:235], v[16:19], v[80:83]
    ds_read_b128 v[48:51], v9 offset:28672
    v_mfma_f32_16x16x32_bf16 v[68:71], v[168:171], v[20:23], v[68:71]
    v_mfma_f32_16x16x32_bf16 v[84:87], v[232:235], v[20:23], v[84:87]
    ds_read_b128 v[52:55], v9 offset:28928
    s_add_u32 s79, s75, 20480
    buffer_load_dwordx4 v[216:219], v6, s[44:47], s79 offen offset:1024 sc1
    v_mfma_f32_16x16x32_bf16 v[72:75], v[168:171], v[24:27], v[72:75]
    v_mfma_f32_16x16x32_bf16 v[88:91], v[232:235], v[24:27], v[88:91]
    ds_read_b128 v[56:59], v9 offset:61440
    v_mfma_f32_16x16x32_bf16 v[76:79], v[168:171], v[28:31], v[76:79]
    v_mfma_f32_16x16x32_bf16 v[92:95], v[232:235], v[28:31], v[92:95]
    ds_read_b128 v[60:63], v9 offset:61696
    v_fma_f32 v13, -v12, v12, v13
    v_max_f32 v13, 0, v13
    v_add_f32 v13, 0x3727c5ac, v13
    v_rsq_f32 v14, v13
    v_mov_b32 v2, s62
    v_mul_f32 v15, -v12, v14
    ds_write_b64 v5, v[14:15]
    ds_read_b64 v[96:97], v4 offset:0
    ds_read_b64 v[98:99], v4 offset:128
    ds_read_b64 v[100:101], v4 offset:256
    ds_read_b64 v[102:103], v4 offset:384
    s_waitcnt lgkmcnt(9)
    v_mfma_f32_16x16x32_bf16 v[64:67], v[172:175], v[32:35], v[64:67]
    v_mfma_f32_16x16x32_bf16 v[80:83], v[236:239], v[32:35], v[80:83]
    ds_read_b128 v[16:19], v9 offset:30720
    v_mfma_f32_16x16x32_bf16 v[68:71], v[172:175], v[36:39], v[68:71]
    v_mfma_f32_16x16x32_bf16 v[84:87], v[236:239], v[36:39], v[84:87]
    ds_read_b128 v[20:23], v9 offset:30976
    v_mfma_f32_16x16x32_bf16 v[72:75], v[172:175], v[40:43], v[72:75]
    v_mfma_f32_16x16x32_bf16 v[88:91], v[236:239], v[40:43], v[88:91]
    ds_read_b128 v[24:27], v9 offset:63488
    v_mfma_f32_16x16x32_bf16 v[76:79], v[172:175], v[44:47], v[76:79]
    v_mfma_f32_16x16x32_bf16 v[92:95], v[236:239], v[44:47], v[92:95]
    ds_read_b128 v[28:31], v9 offset:63744
    ds_read_b64 v[12:13], v124
    ds_read_b64 v[14:15], v124 offset:4608
    ds_read_b64 v[122:123], v125
    s_waitcnt lgkmcnt(12)
    v_mfma_f32_16x16x32_bf16 v[64:67], v[184:187], v[48:51], v[64:67]
    v_mfma_f32_16x16x32_bf16 v[80:83], v[248:251], v[48:51], v[80:83]
    s_waitcnt lgkmcnt(10)
    v_fma_f32 v32, v97, v104, v108
    v_fma_f32 v33, v97, v105, v109
    v_fma_f32 v34, v97, v106, v110
    v_fma_f32 v35, v97, v107, v111
    v_mfma_f32_16x16x32_bf16 v[68:71], v[184:187], v[52:55], v[68:71]
    v_mfma_f32_16x16x32_bf16 v[84:87], v[248:251], v[52:55], v[84:87]
    s_waitcnt lgkmcnt(9)
    v_fma_f32 v36, v99, v104, v108
    v_fma_f32 v37, v99, v105, v109
    v_fma_f32 v38, v99, v106, v110
    v_fma_f32 v39, v99, v107, v111
    v_mfma_f32_16x16x32_bf16 v[72:75], v[184:187], v[56:59], v[72:75]
    v_mfma_f32_16x16x32_bf16 v[88:91], v[248:251], v[56:59], v[88:91]
    s_waitcnt lgkmcnt(8)
    v_fma_f32 v40, v101, v104, v108
    v_fma_f32 v41, v101, v105, v109
    v_fma_f32 v42, v101, v106, v110
    v_fma_f32 v43, v101, v107, v111
    v_mfma_f32_16x16x32_bf16 v[76:79], v[184:187], v[60:63], v[76:79]
    v_mfma_f32_16x16x32_bf16 v[92:95], v[248:251], v[60:63], v[92:95]
    s_waitcnt lgkmcnt(7)
    v_fma_f32 v44, v103, v104, v108
    v_fma_f32 v45, v103, v105, v109
    v_fma_f32 v46, v103, v106, v110
    v_fma_f32 v47, v103, v107, v111
    s_waitcnt lgkmcnt(3)
    v_mfma_f32_16x16x32_bf16 v[64:67], v[188:191], v[16:19], v[64:67]
    v_mfma_f32_16x16x32_bf16 v[80:83], v[252:255], v[16:19], v[80:83]
    v_fma_f32 v48, v97, v112, v116
    v_fma_f32 v49, v97, v113, v117
    v_fma_f32 v50, v97, v114, v118
    v_fma_f32 v51, v97, v115, v119
    v_mfma_f32_16x16x32_bf16 v[68:71], v[188:191], v[20:23], v[68:71]
    v_mfma_f32_16x16x32_bf16 v[84:87], v[252:255], v[20:23], v[84:87]
    v_fma_f32 v52, v99, v112, v116
    v_fma_f32 v53, v99, v113, v117
    v_fma_f32 v54, v99, v114, v118
    v_fma_f32 v55, v99, v115, v119
    v_mfma_f32_16x16x32_bf16 v[72:75], v[188:191], v[24:27], v[72:75]
    v_mfma_f32_16x16x32_bf16 v[88:91], v[252:255], v[24:27], v[88:91]
    v_fma_f32 v56, v101, v112, v116
    v_fma_f32 v57, v101, v113, v117
    v_fma_f32 v58, v101, v114, v118
    v_fma_f32 v59, v101, v115, v119
    v_mfma_f32_16x16x32_bf16 v[76:79], v[188:191], v[28:31], v[76:79]
    v_mfma_f32_16x16x32_bf16 v[92:95], v[252:255], v[28:31], v[92:95]
    v_fma_f32 v60, v103, v112, v116
    v_fma_f32 v61, v103, v113, v117
    v_fma_f32 v62, v103, v114, v118
    v_fma_f32 v63, v103, v115, v119
    v_pk_fma_f32 v[64:65], v[96:97], v[64:65], v[32:33] op_sel_hi:[0,1,1]
    v_pk_fma_f32 v[66:67], v[96:97], v[66:67], v[34:35] op_sel_hi:[0,1,1]
    v_cvt_pk_bf16_f32 v16, v64, v65
    v_cvt_pk_bf16_f32 v17, v66, v67
    v_pk_max_i16 v16, v16, 0
    v_pk_max_i16 v17, v17, 0
    v_pk_fma_f32 v[68:69], v[98:99], v[68:69], v[36:37] op_sel_hi:[0,1,1]
    v_pk_fma_f32 v[70:71], v[98:99], v[70:71], v[38:39] op_sel_hi:[0,1,1]
    v_cvt_pk_bf16_f32 v18, v68, v69
    v_cvt_pk_bf16_f32 v19, v70, v71
    v_pk_max_i16 v18, v18, 0
    v_pk_max_i16 v19, v19, 0
    v_pk_fma_f32 v[72:73], v[100:101], v[72:73], v[40:41] op_sel_hi:[0,1,1]
    v_pk_fma_f32 v[74:75], v[100:101], v[74:75], v[42:43] op_sel_hi:[0,1,1]
    v_cvt_pk_bf16_f32 v20, v72, v73
    v_cvt_pk_bf16_f32 v21, v74, v75
    v_pk_max_i16 v20, v20, 0
    v_pk_max_i16 v21, v21, 0
    v_pk_fma_f32 v[76:77], v[102:103], v[76:77], v[44:45] op_sel_hi:[0,1,1]
    v_pk_fma_f32 v[78:79], v[102:103], v[78:79], v[46:47] op_sel_hi:[0,1,1]
    v_cvt_pk_bf16_f32 v22, v76, v77
    v_cvt_pk_bf16_f32 v23, v78, v79
    v_pk_max_i16 v22, v22, 0
    v_pk_max_i16 v23, v23, 0
    v_permlane16_swap_b32 v16, v18
    v_permlane16_swap_b32 v17, v19
    v_permlane16_swap_b32 v20, v22
    v_permlane16_swap_b32 v21, v23
    s_cmp_eq_u32 s66, 0
    s_cbranch_scc1 L_safe_75
    buffer_store_dwordx4 v[16:19], v6, s[44:47], s15 offen nt
    buffer_store_dwordx4 v[20:23], v6, s[44:47], s16 offen nt
L_pubd_76:
    v_pk_fma_f32 v[80:81], v[96:97], v[80:81], v[48:49] op_sel_hi:[0,1,1]
    v_pk_fma_f32 v[82:83], v[96:97], v[82:83], v[50:51] op_sel_hi:[0,1,1]
    v_cvt_pk_bf16_f32 v24, v80, v81
    v_cvt_pk_bf16_f32 v25, v82, v83
    v_pk_max_i16 v24, v24, 0
    v_pk_max_i16 v25, v25, 0
    v_pk_fma_f32 v[84:85], v[98:99], v[84:85], v[52:53] op_sel_hi:[0,1,1]
    v_pk_fma_f32 v[86:87], v[98:99], v[86:87], v[54:55] op_sel_hi:[0,1,1]
    v_cvt_pk_bf16_f32 v26, v84, v85
    v_cvt_pk_bf16_f32 v27, v86, v87
    v_pk_max_i16 v26, v26, 0
    v_pk_max_i16 v27, v27, 0
    v_pk_fma_f32 v[88:89], v[100:101], v[88:89], v[56:57] op_sel_hi:[0,1,1]
    v_pk_fma_f32 v[90:91], v[100:101], v[90:91], v[58:59] op_sel_hi:[0,1,1]
    v_cvt_pk_bf16_f32 v28, v88, v89
    v_cvt_pk_bf16_f32 v29, v90, v91
    v_pk_max_i16 v28, v28, 0
    v_pk_max_i16 v29, v29, 0
    v_pk_fma_f32 v[92:93], v[102:103], v[92:93], v[60:61] op_sel_hi:[0,1,1]
    v_pk_fma_f32 v[94:95], v[102:103], v[94:95], v[62:63] op_sel_hi:[0,1,1]
    v_cvt_pk_bf16_f32 v30, v92, v93
    v_cvt_pk_bf16_f32 v31, v94, v95
    v_pk_max_i16 v30, v30, 0
    v_pk_max_i16 v31, v31, 0
    v_permlane16_swap_b32 v24, v26
    v_permlane16_swap_b32 v25, v27
    v_permlane16_swap_b32 v28, v30
    v_permlane16_swap_b32 v29, v31
    s_cmp_eq_u32 s66, 0
    s_cbranch_scc1 L_safe_77
    buffer_store_dwordx4 v[24:27], v6, s[44:47], s15 offen offset:1024 nt
    buffer_store_dwordx4 v[28:31], v6, s[44:47], s16 offen offset:1024 nt
    s_waitcnt vmcnt(0)
    s_mov_b64 exec, 1
    buffer_store_dword v2, v6, s[44:47], s17 offen nt
    s_mov_b64 exec, -1
L_pubd_78:
    s_branch L_dDone
L_dB:
    s_add_u32 s76, s7, 299008
    s_add_u32 m0, s8, 102400
    s_nop 0
    buffer_load_dwordx4 v6, s[44:47], s76 offen sc1 lds
    buffer_load_dwordx4 v6, s[44:47], s76 offen offset:1024 sc1 lds
    buffer_load_dwordx4 v6, s[44:47], s76 offen offset:2048 sc1 lds
    buffer_load_dwordx4 v6, s[44:47], s76 offen offset:3072 sc1 lds
    buffer_load_dwordx4 v[64:67], v6, s[44:47], s14 offen offset:0 sc1
    buffer_load_dwordx4 v[68:71], v6, s[44:47], s14 offen offset:1024 sc1
    buffer_load_dwordx4 v[72:75], v6, s[44:47], s14 offen offset:2048 sc1
    buffer_load_dwordx4 v[76:79], v6, s[44:47], s14 offen offset:3072 sc1
    s_cmp_ge_u32 s3, s33
    s_cbranch_scc1 L_dN
    s_setprio 2
    ds_read_b128 v[16:19], v9 offset:0
    ds_read_b128 v[20:23], v9 offset:256
    ds_read_b128 v[24:27], v9 offset:32768
    ds_read_b128 v[28:31], v9 offset:33024
    ds_read_b128 v[32:35], v9 offset:2048
    ds_read_b128 v[36:39], v9 offset:2304
    ds_read_b128 v[40:43], v9 offset:34816
    ds_read_b128 v[44:47], v9 offset:35072
    s_waitcnt lgkmcnt(7)
    v_mfma_f32_16x16x32_bf16 v[80:83], v[192:195], v[16:19], 0
    ds_read_b128 v[48:51], v9 offset:8192
    s_add_u32 s78, s75, 0
    buffer_load_dwordx4 v[128:131], v6, s[44:47], s78 offen offset:0 sc1
    s_waitcnt lgkmcnt(7)
    v_mfma_f32_16x16x32_bf16 v[84:87], v[192:195], v[20:23], 0
    ds_read_b128 v[52:55], v9 offset:8448
    s_waitcnt lgkmcnt(7)
    v_mfma_f32_16x16x32_bf16 v[88:91], v[192:195], v[24:27], 0
    ds_read_b128 v[56:59], v9 offset:40960
    buffer_load_dwordx4 v[132:135], v6, s[44:47], s78 offen offset:2048 sc1
    s_waitcnt lgkmcnt(7)
    v_mfma_f32_16x16x32_bf16 v[92:95], v[192:195], v[28:31], 0
    ds_read_b128 v[60:63], v9 offset:41216
    s_waitcnt lgkmcnt(4)
    v_mfma_f32_16x16x32_bf16 v[80:83], v[196:199], v[32:35], v[80:83]
    ds_read_b128 v[16:19], v9 offset:10240
    s_add_u32 s78, s75, 4096
    buffer_load_dwordx4 v[144:147], v6, s[44:47], s78 offen offset:0 sc1
    v_mfma_f32_16x16x32_bf16 v[84:87], v[196:199], v[36:39], v[84:87]
    ds_read_b128 v[20:23], v9 offset:10496
    v_mfma_f32_16x16x32_bf16 v[88:91], v[196:199], v[40:43], v[88:91]
    ds_read_b128 v[24:27], v9 offset:43008
    buffer_load_dwordx4 v[148:151], v6, s[44:47], s78 offen offset:2048 sc1
    v_mfma_f32_16x16x32_bf16 v[92:95], v[196:199], v[44:47], v[92:95]
    ds_read_b128 v[28:31], v9 offset:43264
    s_waitcnt lgkmcnt(4)
    v_mfma_f32_16x16x32_bf16 v[80:83], v[208:211], v[48:51], v[80:83]
    ds_read_b128 v[32:35], v9 offset:16384
    s_add_u32 s78, s75, 8192
    buffer_load_dwordx4 v[160:163], v6, s[44:47], s78 offen offset:0 sc1
    v_mfma_f32_16x16x32_bf16 v[84:87], v[208:211], v[52:55], v[84:87]
    ds_read_b128 v[36:39], v9 offset:16640
    v_mfma_f32_16x16x32_bf16 v[88:91], v[208:211], v[56:59], v[88:91]
    ds_read_b128 v[40:43], v9 offset:49152
    buffer_load_dwordx4 v[164:167], v6, s[44:47], s78 offen offset:2048 sc1
    v_mfma_f32_16x16x32_bf16 v[92:95], v[208:211], v[60:63], v[92:95]
    ds_read_b128 v[44:47], v9 offset:49408
    s_waitcnt lgkmcnt(4)
    v_mfma_f32_16x16x32_bf16 v[80:83], v[212:215], v[16:19], v[80:83]
    ds_read_b128 v[48:51], v9 offset:18432
    s_add_u32 s78, s75, 12288
    buffer_load_dwordx4 v[176:179], v6, s[44:47], s78 offen offset:0 sc1
    v_mfma_f32_16x16x32_bf16 v[84:87], v[212:215], v[20:23], v[84:87]
    ds_read_b128 v[52:55], v9 offset:18688
    v_mfma_f32_16x16x32_bf16 v[88:91], v[212:215], v[24:27], v[88:91]
    ds_read_b128 v[56:59], v9 offset:51200
    buffer_load_dwordx4 v[180:183], v6, s[44:47], s78 offen offset:2048 sc1
    v_mfma_f32_16x16x32_bf16 v[92:95], v[212:215], v[28:31], v[92:95]
    ds_read_b128 v[60:63], v9 offset:51456
    s_waitcnt lgkmcnt(4)
    v_mfma_f32_16x16x32_bf16 v[80:83], v[224:227], v[32:35], v[80:83]
    ds_read_b128 v[16:19], v9 offset:24576
    s_add_u32 s78, s75, 16384
    buffer_load_dwordx4 v[136:139], v6, s[44:47], s78 offen offset:0 sc1
    v_mfma_f32_16x16x32_bf16 v[84:87], v[224:227], v[36:39], v[84:87]
    ds_read_b128 v[20:23], v9 offset:24832
    v_mfma_f32_16x16x32_bf16 v[88:91], v[224:227], v[40:43], v[88:91]
    ds_read_b128 v[24:27], v9 offset:57344
    buffer_load_dwordx4 v[140:143], v6, s[44:47], s78 offen offset:2048 sc1
    v_mfma_f32_16x16x32_bf16 v[92:95], v[224:227], v[44:47], v[92:95]
    ds_read_b128 v[28:31], v9 offset:57600
    s_waitcnt lgkmcnt(4)
    v_mfma_f32_16x16x32_bf16 v[80:83], v[228:231], v[48:51], v[80:83]
    ds_read_b128 v[32:35], v9 offset:26624
    s_add_u32 s78, s75, 20480
    buffer_load_dwordx4 v[152:155], v6, s[44:47], s78 offen offset:0 sc1
    v_mfma_f32_16x16x32_bf16 v[84:87], v[228:231], v[52:55], v[84:87]
    ds_read_b128 v[36:39], v9 offset:26880
    v_mfma_f32_16x16x32_bf16 v[88:91], v[228:231], v[56:59], v[88:91]
    ds_read_b128 v[40:43], v9 offset:59392
    v_mfma_f32_16x16x32_bf16 v[92:95], v[228:231], v[60:63], v[92:95]
    ds_read_b128 v[44:47], v9 offset:59648
    s_waitcnt vmcnt(13)
    v_add_f32 v64, v64, v68
    s_waitcnt vmcnt(11)
    v_add_f32 v72, v72, v76
    v_add_f32 v65, v65, v69
    v_add_f32 v73, v73, v77
    v_add_f32 v66, v66, v70
    v_add_f32 v74, v74, v78
    v_add_f32 v67, v67, v71
    v_add_f32 v75, v75, v79
    v_add_f32 v64, v64, v72
    v_add_f32 v65, v65, v73
    v_add_f32 v66, v66, v74
    v_add_f32 v67, v67, v75
    ds_write_b128 v1, v[64:67]
    s_waitcnt lgkmcnt(0)
    s_barrier
    v_mfma_f32_16x16x32_bf16 v[80:83], v[240:243], v[16:19], v[80:83]
    ds_read_b128 v[48:51], v9 offset:4096
    v_mfma_f32_16x16x32_bf16 v[84:87], v[240:243], v[20:23], v[84:87]
    ds_read_b128 v[52:55], v9 offset:4352
    s_add_u32 s79, s75, 0
    buffer_load_dwordx4 v[192:195], v6, s[44:47], s79 offen offset:1024 sc1
    v_mfma_f32_16x16x32_bf16 v[88:91], v[240:243], v[24:27], v[88:91]
    ds_read_b128 v[56:59], v9 offset:36864
    v_mfma_f32_16x16x32_bf16 v[92:95], v[240:243], v[28:31], v[92:95]
    ds_read_b128 v[60:63], v9 offset:37120
    buffer_load_dwordx4 v[196:199], v6, s[44:47], s79 offen offset:3072 sc1
    v_mfma_f32_16x16x32_bf16 v[80:83], v[244:247], v[32:35], v[80:83]
    ds_read_b128 v[16:19], v9 offset:6144
    v_mfma_f32_16x16x32_bf16 v[84:87], v[244:247], v[36:39], v[84:87]
    ds_read_b128 v[20:23], v9 offset:6400
    s_add_u32 s79, s75, 4096
    buffer_load_dwordx4 v[208:211], v6, s[44:47], s79 offen offset:1024 sc1
    v_mfma_f32_16x16x32_bf16 v[88:91], v[244:247], v[40:43], v[88:91]
    ds_read_b128 v[24:27], v9 offset:38912
    v_mfma_f32_16x16x32_bf16 v[92:95], v[244:247], v[44:47], v[92:95]
    ds_read_b128 v[28:31], v9 offset:39168
    buffer_load_dwordx4 v[212:215], v6, s[44:47], s79 offen offset:3072 sc1
    ds_read_b64 v[96:97], v11 offset:0
    ds_read_b64 v[98:99], v11 offset:512
    ds_read_b64 v[100:101], v11 offset:1024
    ds_read_b64 v[102:103], v11 offset:1536
    s_waitcnt lgkmcnt(8)
    v_mfma_f32_16x16x32_bf16 v[80:83], v[200:203], v[48:51], v[80:83]
    ds_read_b128 v[32:35], v9 offset:12288
    v_mfma_f32_16x16x32_bf16 v[84:87], v[200:203], v[52:55], v[84:87]
    ds_read_b128 v[36:39], v9 offset:12544
    s_add_u32 s79, s75, 8192
    buffer_load_dwordx4 v[224:227], v6, s[44:47], s79 offen offset:1024 sc1
    v_mfma_f32_16x16x32_bf16 v[88:91], v[200:203], v[56:59], v[88:91]
    ds_read_b128 v[40:43], v9 offset:45056
    v_mfma_f32_16x16x32_bf16 v[92:95], v[200:203], v[60:63], v[92:95]
    ds_read_b128 v[44:47], v9 offset:45312
    buffer_load_dwordx4 v[228:231], v6, s[44:47], s79 offen offset:3072 sc1
    s_waitcnt lgkmcnt(8)
    v_mfma_f32_16x16x32_bf16 v[80:83], v[204:207], v[16:19], v[80:83]
    ds_read_b128 v[48:51], v9 offset:14336
    v_mfma_f32_16x16x32_bf16 v[84:87], v[204:207], v[20:23], v[84:87]
    ds_read_b128 v[52:55], v9 offset:14592
    s_add_u32 s79, s75, 12288
    buffer_load_dwordx4 v[240:243], v6, s[44:47], s79 offen offset:1024 sc1
    v_mfma_f32_16x16x32_bf16 v[88:91], v[204:207], v[24:27], v[88:91]
    ds_read_b128 v[56:59], v9 offset:47104
    v_mfma_f32_16x16x32_bf16 v[92:95], v[204:207], v[28:31], v[92:95]
    ds_read_b128 v[60:63], v9 offset:47360
    buffer_load_dwordx4 v[244:247], v6, s[44:47], s79 offen offset:3072 sc1
    s_waitcnt lgkmcnt(10)
    v_add_f32 v96, v96, v98
    v_add_f32 v97, v97, v99
    s_waitcnt lgkmcnt(8)
    v_add_f32 v100, v100, v102
    v_add_f32 v101, v101, v103
    v_add_f32 v12, v96, v100
    v_add_f32 v13, v97, v101
    ds_read_b64 v[96:97], v11 offset:2048
    ds_read_b64 v[98:99], v11 offset:2560
    ds_read_b64 v[100:101], v11 offset:3072
    ds_read_b64 v[102:103], v11 offset:3584
    s_waitcnt lgkmcnt(8)
    v_mfma_f32_16x16x32_bf16 v[80:83], v[216:219], v[32:35], v[80:83]
    ds_read_b128 v[16:19], v9 offset:20480
    v_mfma_f32_16x16x32_bf16 v[84:87], v[216:219], v[36:39], v[84:87]
    ds_read_b128 v[20:23], v9 offset:20736
    s_add_u32 s79, s75, 16384
    buffer_load_dwordx4 v[200:203], v6, s[44:47], s79 offen offset:1024 sc1
    v_mfma_f32_16x16x32_bf16 v[88:91], v[216:219], v[40:43], v[88:91]
    ds_read_b128 v[24:27], v9 offset:53248
    v_mfma_f32_16x16x32_bf16 v[92:95], v[216:219], v[44:47], v[92:95]
    ds_read_b128 v[28:31], v9 offset:53504
    buffer_load_dwordx4 v[204:207], v6, s[44:47], s79 offen offset:3072 sc1
    s_waitcnt lgkmcnt(8)
    v_mfma_f32_16x16x32_bf16 v[80:83], v[220:223], v[48:51], v[80:83]
    ds_read_b128 v[32:35], v9 offset:22528
    v_mfma_f32_16x16x32_bf16 v[84:87], v[220:223], v[52:55], v[84:87]
    ds_read_b128 v[36:39], v9 offset:22784
    s_add_u32 s79, s75, 20480
    buffer_load_dwordx4 v[216:219], v6, s[44:47], s79 offen offset:1024 sc1
    v_mfma_f32_16x16x32_bf16 v[88:91], v[220:223], v[56:59], v[88:91]
    ds_read_b128 v[40:43], v9 offset:55296
    v_mfma_f32_16x16x32_bf16 v[92:95], v[220:223], v[60:63], v[92:95]
    ds_read_b128 v[44:47], v9 offset:55552
    s_waitcnt lgkmcnt(10)
    v_add_f32 v96, v96, v98
    v_add_f32 v97, v97, v99
    s_waitcnt lgkmcnt(8)
    v_add_f32 v100, v100, v102
    v_add_f32 v101, v101, v103
    v_add_f32 v12, v12, v96
    v_add_f32 v13, v13, v97
    v_add_f32 v12, v12, v100
    v_add_f32 v13, v13, v101
    v_mul_f32 v12, 0x3b000000, v12
    v_mul_f32 v13, 0x3b000000, v13
    s_waitcnt lgkmcnt(4)
    v_mfma_f32_16x16x32_bf16 v[80:83], v[232:235], v[16:19], v[80:83]
    ds_read_b128 v[48:51], v9 offset:28672
    v_mfma_f32_16x16x32_bf16 v[84:87], v[232:235], v[20:23], v[84:87]
    ds_read_b128 v[52:55], v9 offset:28928
    v_mfma_f32_16x16x32_bf16 v[88:91], v[232:235], v[24:27], v[88:91]
    ds_read_b128 v[56:59], v9 offset:61440
    v_mfma_f32_16x16x32_bf16 v[92:95], v[232:235], v[28:31], v[92:95]
    ds_read_b128 v[60:63], v9 offset:61696
    v_fma_f32 v13, -v12, v12, v13
    v_max_f32 v13, 0, v13
    v_add_f32 v13, 0x3727c5ac, v13
    v_rsq_f32 v14, v13
    v_mov_b32 v2, s62
    v_mul_f32 v15, -v12, v14
    ds_write_b64 v5, v[14:15]
    ds_read_b64 v[96:97], v4 offset:0
    ds_read_b64 v[98:99], v4 offset:128
    ds_read_b64 v[100:101], v4 offset:256
    ds_read_b64 v[102:103], v4 offset:384
    s_waitcnt lgkmcnt(9)
    v_mfma_f32_16x16x32_bf16 v[80:83], v[236:239], v[32:35], v[80:83]
    ds_read_b128 v[16:19], v9 offset:30720
    v_mfma_f32_16x16x32_bf16 v[84:87], v[236:239], v[36:39], v[84:87]
    ds_read_b128 v[20:23], v9 offset:30976
    v_mfma_f32_16x16x32_bf16 v[88:91], v[236:239], v[40:43], v[88:91]
    ds_read_b128 v[24:27], v9 offset:63488
    v_mfma_f32_16x16x32_bf16 v[92:95], v[236:239], v[44:47], v[92:95]
    ds_read_b128 v[28:31], v9 offset:63744
    ds_read_b64 v[12:13], v124
    ds_read_b64 v[14:15], v124 offset:4608
    ds_read_b64 v[122:123], v125
    s_waitcnt lgkmcnt(12)
    v_mfma_f32_16x16x32_bf16 v[80:83], v[248:251], v[48:51], v[80:83]
    v_mfma_f32_16x16x32_bf16 v[84:87], v[248:251], v[52:55], v[84:87]
    v_mfma_f32_16x16x32_bf16 v[88:91], v[248:251], v[56:59], v[88:91]
    v_mfma_f32_16x16x32_bf16 v[92:95], v[248:251], v[60:63], v[92:95]
    s_waitcnt lgkmcnt(3)
    v_mfma_f32_16x16x32_bf16 v[80:83], v[252:255], v[16:19], v[80:83]
    v_fma_f32 v48, v97, v112, v116
    v_fma_f32 v49, v97, v113, v117
    v_fma_f32 v50, v97, v114, v118
    v_fma_f32 v51, v97, v115, v119
    v_mfma_f32_16x16x32_bf16 v[84:87], v[252:255], v[20:23], v[84:87]
    v_fma_f32 v52, v99, v112, v116
    v_fma_f32 v53, v99, v113, v117
    v_fma_f32 v54, v99, v114, v118
    v_fma_f32 v55, v99, v115, v119
    v_mfma_f32_16x16x32_bf16 v[88:91], v[252:255], v[24:27], v[88:91]
    v_fma_f32 v56, v101, v112, v116
    v_fma_f32 v57, v101, v113, v117
    v_fma_f32 v58, v101, v114, v118
    v_fma_f32 v59, v101, v115, v119
    v_mfma_f32_16x16x32_bf16 v[92:95], v[252:255], v[28:31], v[92:95]
    v_fma_f32 v60, v103, v112, v116
    v_fma_f32 v61, v103, v113, v117
    v_fma_f32 v62, v103, v114, v118
    v_fma_f32 v63, v103, v115, v119
    v_fma_f32 v80, v96, v80, v48
    v_fma_f32 v81, v96, v81, v49
    v_fma_f32 v82, v96, v82, v50
    v_fma_f32 v83, v96, v83, v51
    v_cvt_pk_bf16_f32 v24, v80, v81
    v_cvt_pk_bf16_f32 v25, v82, v83
    v_pk_max_i16 v24, v24, 0
    v_pk_max_i16 v25, v25, 0
    v_fma_f32 v84, v98, v84, v52
    v_fma_f32 v85, v98, v85, v53
    v_fma_f32 v86, v98, v86, v54
    v_fma_f32 v87, v98, v87, v55
    v_cvt_pk_bf16_f32 v26, v84, v85
    v_cvt_pk_bf16_f32 v27, v86, v87
    v_pk_max_i16 v26, v26, 0
    v_pk_max_i16 v27, v27, 0
    v_fma_f32 v88, v100, v88, v56
    v_fma_f32 v89, v100, v89, v57
    v_fma_f32 v90, v100, v90, v58
    v_fma_f32 v91, v100, v91, v59
    v_cvt_pk_bf16_f32 v28, v88, v89
    v_cvt_pk_bf16_f32 v29, v90, v91
    v_pk_max_i16 v28, v28, 0
    v_pk_max_i16 v29, v29, 0
    v_fma_f32 v92, v102, v92, v60
    v_fma_f32 v93, v102, v93, v61
    v_fma_f32 v94, v102, v94, v62
    v_fma_f32 v95, v102, v95, v63
    v_cvt_pk_bf16_f32 v30, v92, v93
    v_cvt_pk_bf16_f32 v31, v94, v95
    v_pk_max_i16 v30, v30, 0
    v_pk_max_i16 v31, v31, 0
    v_permlane16_swap_b32 v24, v26
    v_permlane16_swap_b32 v25, v27
    v_permlane16_swap_b32 v28, v30
    v_permlane16_swap_b32 v29, v31
    s_cmp_eq_u32 s66, 0
    s_cbranch_scc1 L_safe_79
    buffer_store_dwordx4 v[24:27], v6, s[44:47], s15 offen nt
    buffer_store_dwordx4 v[28:31], v6, s[44:47], s16 offen nt
    s_waitcnt vmcnt(0)
    s_mov_b64 exec, 1
    buffer_store_dword v2, v6, s[44:47], s17 offen nt
    s_mov_b64 exec, -1
L_pubd_80:
    s_branch L_dDone
L_dN:
    v_mov_b32 v2, s62
    s_cmp_eq_u32 s66, 0
    s_cbranch_scc1 L_safe_81
    s_mov_b64 exec, 1
    buffer_store_dword v2, v6, s[44:47], s17 offen nt
    s_mov_b64 exec, -1
L_pubd_82:
    s_waitcnt vmcnt(3)
    v_add_f32 v64, v64, v68
    s_waitcnt vmcnt(1)
    v_add_f32 v72, v72, v76
    v_add_f32 v65, v65, v69
    v_add_f32 v73, v73, v77
    v_add_f32 v66, v66, v70
    v_add_f32 v74, v74, v78
    v_add_f32 v67, v67, v71
    v_add_f32 v75, v75, v79
    v_add_f32 v64, v64, v72
    v_add_f32 v65, v65, v73
    v_add_f32 v66, v66, v74
    v_add_f32 v67, v67, v75
    ds_write_b128 v1, v[64:67]
    s_waitcnt lgkmcnt(0)
    s_barrier
    s_add_u32 s78, s75, 0
    buffer_load_dwordx4 v[128:131], v6, s[44:47], s78 offen offset:0 sc1
    s_add_u32 s79, s75, 0
    buffer_load_dwordx4 v[192:195], v6, s[44:47], s79 offen offset:1024 sc1
    buffer_load_dwordx4 v[132:135], v6, s[44:47], s78 offen offset:2048 sc1
    buffer_load_dwordx4 v[196:199], v6, s[44:47], s79 offen offset:3072 sc1
    s_add_u32 s78, s75, 4096
    buffer_load_dwordx4 v[144:147], v6, s[44:47], s78 offen offset:0 sc1
    s_add_u32 s79, s75, 4096
    buffer_load_dwordx4 v[208:211], v6, s[44:47], s79 offen offset:1024 sc1
    buffer_load_dwordx4 v[148:151], v6, s[44:47], s78 offen offset:2048 sc1
    buffer_load_dwordx4 v[212:215], v6, s[44:47], s79 offen offset:3072 sc1
    s_add_u32 s78, s75, 8192
    buffer_load_dwordx4 v[160:163], v6, s[44:47], s78 offen offset:0 sc1
    s_add_u32 s79, s75, 8192
    buffer_load_dwordx4 v[224:227], v6, s[44:47], s79 offen offset:1024 sc1
    buffer_load_dwordx4 v[164:167], v6, s[44:47], s78 offen offset:2048 sc1
    buffer_load_dwordx4 v[228:231], v6, s[44:47], s79 offen offset:3072 sc1
    s_add_u32 s78, s75, 12288
    buffer_load_dwordx4 v[176:179], v6, s[44:47], s78 offen offset:0 sc1
    s_add_u32 s79, s75, 12288
    buffer_load_dwordx4 v[240:243], v6, s[44:47], s79 offen offset:1024 sc1
    buffer_load_dwordx4 v[180:183], v6, s[44:47], s78 offen offset:2048 sc1
    buffer_load_dwordx4 v[244:247], v6, s[44:47], s79 offen offset:3072 sc1
    s_add_u32 s78, s75, 16384
    buffer_load_dwordx4 v[136:139], v6, s[44:47], s78 offen offset:0 sc1
    s_add_u32 s79, s75, 16384
    buffer_load_dwordx4 v[200:203], v6, s[44:47], s79 offen offset:1024 sc1
    buffer_load_dwordx4 v[140:143], v6, s[44:47], s78 offen offset:2048 sc1
    buffer_load_dwordx4 v[204:207], v6, s[44:47], s79 offen offset:3072 sc1
    s_add_u32 s78, s75, 20480
    buffer_load_dwordx4 v[152:155], v6, s[44:47], s78 offen offset:0 sc1
    s_add_u32 s79, s75, 20480
    buffer_load_dwordx4 v[216:219], v6, s[44:47], s79 offen offset:1024 sc1
    ds_read_b64 v[12:13], v124
    ds_read_b64 v[14:15], v124 offset:4608
    ds_read_b64 v[122:123], v125
L_dDone:
    s_setprio 0
    v_and_b32 v1, 31, v0
    v_lshlrev_b32 v1, 2, v1
    s_lshl_b32 s78, s26, 14
    v_add_u32 v10, s78, v9
    v_subrev_u32 v9, 65536, v10
    s_lshl_b32 s78, s3, 12
    s_waitcnt lgkmcnt(0)
    s_barrier
    s_mov_b32 s67, 0x40000
L_poll_83:
    buffer_load_dword v2, v1, s[44:47], s18 offen sc1
    s_sub_u32 s67, s67, 1
    s_cbranch_scc1 L_polld_84
    s_waitcnt vmcnt(0)
    v_cmp_ne_u32 vcc, s62, v2
    s_nop 0
    s_cbranch_vccnz L_poll_83
L_polld_84:
    s_waitcnt vmcnt(0)
    s_setprio 1
    s_add_u32 m0, s78, 0
    s_add_u32 s76, s19, 0
    buffer_load_dwordx4 v6, s[44:47], s76 offen sc1 lds
    buffer_load_dwordx4 v6, s[44:47], s76 offen offset:1024 sc1 lds
    buffer_load_dwordx4 v6, s[44:47], s76 offen offset:2048 sc1 lds
    buffer_load_dwordx4 v6, s[44:47], s76 offen offset:3072 sc1 lds
    s_setprio 0
    s_add_u32 m0, s78, 32768
    s_add_u32 s76, s19, 8192
    buffer_load_dwordx4 v6, s[44:47], s76 offen sc1 lds
    buffer_load_dwordx4 v6, s[44:47], s76 offen offset:1024 sc1 lds
    v_mul_u32_u24 v3, 272, v8
    v_lshl_add_u32 v3, v7, 4, v3
    s_mul_i32 s77, s26, 17408
    s_and_b32 s79, s3, 3
    s_lshl_b32 s79, s79, 6
    s_add_u32 s77, s77, s79
    s_add_u32 s77, s77, 65536
    v_add_u32 v11, s77, v3
    v_mul_u32_u24 v3, 272, v7
    v_lshl_add_u32 v3, v8, 4, v3
    s_mul_i32 s77, s3, 1088
    s_add_u32 s77, s77, 65536
    v_add_u32 v5, s77, v3
    v_lshlrev_b32 v4, 10, v7
    v_lshl_add_u32 v4, v8, 3, v4
    v_lshlrev_b32 v120, 16, v122
    v_and_b32 v121, 0xffff0000, v122
    v_lshlrev_b32 v122, 16, v123
    v_and_b32 v123, 0xffff0000, v123
    v_lshlrev_b32 v80, 16, v12
    v_and_b32 v81, 0xffff0000, v12
    v_lshlrev_b32 v82, 16, v13
    v_and_b32 v83, 0xffff0000, v13
    v_lshlrev_b32 v84, 16, v14
    v_and_b32 v85, 0xffff0000, v14
    v_lshlrev_b32 v86, 16, v15
    v_and_b32 v87, 0xffff0000, v15
    s_waitcnt vmcnt(2)
    s_barrier
    ds_read_b128 v[16:19], v9 offset:0
    ds_read_b128 v[20:23], v9 offset:256
    ds_read_b128 v[24:27], v9 offset:8192
    ds_read_b128 v[28:31], v9 offset:8448
    ds_read_b128 v[32:35], v9 offset:2048
    ds_read_b128 v[36:39], v9 offset:2304
    ds_read_b128 v[40:43], v9 offset:10240
    ds_read_b128 v[44:47], v9 offset:10496
    s_waitcnt lgkmcnt(7)
    v_mfma_f32_16x16x32_bf16 v[64:67], v[128:131], v[16:19], 0
    ds_read_b128 v[48:51], v9 offset:4096
    s_waitcnt lgkmcnt(7)
    v_mfma_f32_16x16x32_bf16 v[68:71], v[128:131], v[20:23], 0
    ds_read_b128 v[52:55], v9 offset:4352
    buffer_load_dwordx4 v6, s[44:47], s76 offen offset:2048 sc1 lds
    s_waitcnt lgkmcnt(7)
    v_mfma_f32_16x16x32_bf16 v[72:75], v[128:131], v[24:27], 0
    ds_read_b128 v[56:59], v9 offset:12288
    s_waitcnt lgkmcnt(7)
    v_mfma_f32_16x16x32_bf16 v[76:79], v[128:131], v[28:31], 0
    ds_read_b128 v[60:63], v9 offset:12544
    buffer_load_dwordx4 v6, s[44:47], s76 offen offset:3072 sc1 lds
    s_waitcnt lgkmcnt(4)
    v_mfma_f32_16x16x32_bf16 v[64:67], v[192:195], v[32:35], v[64:67]
    ds_read_b128 v[16:19], v9 offset:6144
    v_mfma_f32_16x16x32_bf16 v[68:71], v[192:195], v[36:39], v[68:71]
    ds_read_b128 v[20:23], v9 offset:6400
    s_add_u32 m0, s78, 65536
    s_add_u32 s76, s19, 16384
    buffer_load_dwordx4 v6, s[44:47], s76 offen sc1 lds
    v_mfma_f32_16x16x32_bf16 v[72:75], v[192:195], v[40:43], v[72:75]
    ds_read_b128 v[24:27], v9 offset:14336
    v_mfma_f32_16x16x32_bf16 v[76:79], v[192:195], v[44:47], v[76:79]
    ds_read_b128 v[28:31], v9 offset:14592
    buffer_load_dwordx4 v6, s[44:47], s76 offen offset:1024 sc1 lds
    s_waitcnt vmcnt(2)
    s_barrier
    s_waitcnt lgkmcnt(4)
    v_mfma_f32_16x16x32_bf16 v[64:67], v[132:135], v[48:51], v[64:67]
    ds_read_b128 v[32:35], v9 offset:32768
    v_mfma_f32_16x16x32_bf16 v[68:71], v[132:135], v[52:55], v[68:71]
    ds_read_b128 v[36:39], v9 offset:33024
    buffer_load_dwordx4 v6, s[44:47], s76 offen offset:2048 sc1 lds
    v_mfma_f32_16x16x32_bf16 v[72:75], v[132:135], v[56:59], v[72:75]
    ds_read_b128 v[40:43], v9 offset:40960
    v_mfma_f32_16x16x32_bf16 v[76:79], v[132:135], v[60:63], v[76:79]
    ds_read_b128 v[44:47], v9 offset:41216
    buffer_load_dwordx4 v6, s[44:47], s76 offen offset:3072 sc1 lds
    s_waitcnt lgkmcnt(4)
    v_mfma_f32_16x16x32_bf16 v[64:67], v[196:199], v[16:19], v[64:67]
    ds_read_b128 v[48:51], v9 offset:34816
    v_mfma_f32_16x16x32_bf16 v[68:71], v[196:199], v[20:23], v[68:71]
    ds_read_b128 v[52:55], v9 offset:35072
    s_add_u32 m0, s78, 98304
    s_add_u32 s76, s19, 24576
    buffer_load_dwordx4 v6, s[44:47], s76 offen sc1 lds
    v_mfma_f32_16x16x32_bf16 v[72:75], v[196:199], v[24:27], v[72:75]
    ds_read_b128 v[56:59], v9 offset:43008
    v_mfma_f32_16x16x32_bf16 v[76:79], v[196:199], v[28:31], v[76:79]
    ds_read_b128 v[60:63], v9 offset:43264
    buffer_load_dwordx4 v6, s[44:47], s76 offen offset:1024 sc1 lds
    s_waitcnt lgkmcnt(4)
    v_mfma_f32_16x16x32_bf16 v[64:67], v[144:147], v[32:35], v[64:67]
    ds_read_b128 v[16:19], v9 offset:36864
    v_mfma_f32_16x16x32_bf16 v[68:71], v[144:147], v[36:39], v[68:71]
    ds_read_b128 v[20:23], v9 offset:37120
    buffer_load_dwordx4 v6, s[44:47], s76 offen offset:2048 sc1 lds
    v_mfma_f32_16x16x32_bf16 v[72:75], v[144:147], v[40:43], v[72:75]
    ds_read_b128 v[24:27], v9 offset:45056
    v_mfma_f32_16x16x32_bf16 v[76:79], v[144:147], v[44:47], v[76:79]
    ds_read_b128 v[28:31], v9 offset:45312
    s_waitcnt lgkmcnt(4)
    v_mfma_f32_16x16x32_bf16 v[64:67], v[208:211], v[48:51], v[64:67]
    ds_read_b128 v[32:35], v9 offset:38912
    v_mfma_f32_16x16x32_bf16 v[68:71], v[208:211], v[52:55], v[68:71]
    ds_read_b128 v[36:39], v9 offset:39168
    buffer_load_dwordx4 v6, s[44:47], s76 offen offset:3072 sc1 lds
    v_mfma_f32_16x16x32_bf16 v[72:75], v[208:211], v[56:59], v[72:75]
    ds_read_b128 v[40:43], v9 offset:47104
    v_mfma_f32_16x16x32_bf16 v[76:79], v[208:211], v[60:63], v[76:79]
    ds_read_b128 v[44:47], v9 offset:47360
    s_waitcnt vmcnt(4)
    s_barrier
    s_waitcnt lgkmcnt(4)
    v_mfma_f32_16x16x32_bf16 v[64:67], v[148:151], v[16:19], v[64:67]
    ds_read_b128 v[48:51], v10 offset:0
    v_mfma_f32_16x16x32_bf16 v[68:71], v[148:151], v[20:23], v[68:71]
    ds_read_b128 v[52:55], v10 offset:256
    s_add_u32 m0, s78, 0
    s_add_u32 s76, s19, 32768
    buffer_load_dwordx4 v6, s[44:47], s76 offen sc1 lds
    v_mfma_f32_16x16x32_bf16 v[72:75], v[148:151], v[24:27], v[72:75]
    ds_read_b128 v[56:59], v10 offset:8192
    v_mfma_f32_16x16x32_bf16 v[76:79], v[148:151], v[28:31], v[76:79]
    ds_read_b128 v[60:63], v10 offset:8448
    s_waitcnt lgkmcnt(4)
    v_mfma_f32_16x16x32_bf16 v[64:67], v[212:215], v[32:35], v[64:67]
    ds_read_b128 v[16:19], v10 offset:2048
    v_mfma_f32_16x16x32_bf16 v[68:71], v[212:215], v[36:39], v[68:71]
    ds_read_b128 v[20:23], v10 offset:2304
    buffer_load_dwordx4 v6, s[44:47], s76 offen offset:1024 sc1 lds
    v_mfma_f32_16x16x32_bf16 v[72:75], v[212:215], v[40:43], v[72:75]
    ds_read_b128 v[24:27], v10 offset:10240
    v_mfma_f32_16x16x32_bf16 v[76:79], v[212:215], v[44:47], v[76:79]
    ds_read_b128 v[28:31], v10 offset:10496
    s_waitcnt lgkmcnt(4)
    v_mfma_f32_16x16x32_bf16 v[64:67], v[160:163], v[48:51], v[64:67]
    ds_read_b128 v[32:35], v10 offset:4096
    v_mfma_f32_16x16x32_bf16 v[68:71], v[160:163], v[52:55], v[68:71]
    ds_read_b128 v[36:39], v10 offset:4352
    buffer_load_dwordx4 v6, s[44:47], s76 offen offset:2048 sc1 lds
    v_mfma_f32_16x16x32_bf16 v[72:75], v[160:163], v[56:59], v[72:75]
    ds_read_b128 v[40:43], v10 offset:12288
    v_mfma_f32_16x16x32_bf16 v[76:79], v[160:163], v[60:63], v[76:79]
    ds_read_b128 v[44:47], v10 offset:12544
    s_waitcnt lgkmcnt(4)
    v_mfma_f32_16x16x32_bf16 v[64:67], v[224:227], v[16:19], v[64:67]
    ds_read_b128 v[48:51], v10 offset:6144
    v_mfma_f32_16x16x32_bf16 v[68:71], v[224:227], v[20:23], v[68:71]
    ds_read_b128 v[52:55], v10 offset:6400
    buffer_load_dwordx4 v6, s[44:47], s76 offen offset:3072 sc1 lds
    v_mfma_f32_16x16x32_bf16 v[72:75], v[224:227], v[24:27], v[72:75]
    ds_read_b128 v[56:59], v10 offset:14336
    v_mfma_f32_16x16x32_bf16 v[76:79], v[224:227], v[28:31], v[76:79]
    ds_read_b128 v[60:63], v10 offset:14592
    s_waitcnt vmcnt(4)
    s_barrier
    s_waitcnt lgkmcnt(4)
    v_mfma_f32_16x16x32_bf16 v[64:67], v[164:167], v[32:35], v[64:67]
    ds_read_b128 v[16:19], v10 offset:32768
    v_mfma_f32_16x16x32_bf16 v[68:71], v[164:167], v[36:39], v[68:71]
    ds_read_b128 v[20:23], v10 offset:33024
    s_bitcmp1_b32 s3, 0
    s_cselect_b32 s19, 28311552, s19
    s_add_u32 m0, s78, 32768
    s_add_u32 s76, s19, 40960
    buffer_load_dwordx4 v6, s[44:47], s76 offen sc1 lds
    v_mfma_f32_16x16x32_bf16 v[72:75], v[164:167], v[40:43], v[72:75]
    ds_read_b128 v[24:27], v10 offset:40960
    v_mfma_f32_16x16x32_bf16 v[76:79], v[164:167], v[44:47], v[76:79]
    ds_read_b128 v[28:31], v10 offset:41216
    s_waitcnt lgkmcnt(4)
    v_mfma_f32_16x16x32_bf16 v[64:67], v[228:231], v[48:51], v[64:67]
    ds_read_b128 v[32:35], v10 offset:34816
    v_mfma_f32_16x16x32_bf16 v[68:71], v[228:231], v[52:55], v[68:71]
    ds_read_b128 v[36:39], v10 offset:35072
    buffer_load_dwordx4 v6, s[44:47], s76 offen offset:1024 sc1 lds
    v_mfma_f32_16x16x32_bf16 v[72:75], v[228:231], v[56:59], v[72:75]
    ds_read_b128 v[40:43], v10 offset:43008
    v_mfma_f32_16x16x32_bf16 v[76:79], v[228:231], v[60:63], v[76:79]
    ds_read_b128 v[44:47], v10 offset:43264
    s_waitcnt lgkmcnt(4)
    v_mfma_f32_16x16x32_bf16 v[64:67], v[176:179], v[16:19], v[64:67]
    ds_read_b128 v[48:51], v10 offset:36864
    v_mfma_f32_16x16x32_bf16 v[68:71], v[176:179], v[20:23], v[68:71]
    ds_read_b128 v[52:55], v10 offset:37120
    buffer_load_dwordx4 v6, s[44:47], s76 offen offset:2048 sc1 lds
    v_mfma_f32_16x16x32_bf16 v[72:75], v[176:179], v[24:27], v[72:75]
    ds_read_b128 v[56:59], v10 offset:45056
    v_mfma_f32_16x16x32_bf16 v[76:79], v[176:179], v[28:31], v[76:79]
    ds_read_b128 v[60:63], v10 offset:45312
    s_waitcnt lgkmcnt(4)
    v_mfma_f32_16x16x32_bf16 v[64:67], v[240:243], v[32:35], v[64:67]
    ds_read_b128 v[16:19], v10 offset:38912
    v_mfma_f32_16x16x32_bf16 v[68:71], v[240:243], v[36:39], v[68:71]
    ds_read_b128 v[20:23], v10 offset:39168
    buffer_load_dwordx4 v6, s[44:47], s76 offen offset:3072 sc1 lds
    v_mfma_f32_16x16x32_bf16 v[72:75], v[240:243], v[40:43], v[72:75]
    ds_read_b128 v[24:27], v10 offset:47104
    v_mfma_f32_16x16x32_bf16 v[76:79], v[240:243], v[44:47], v[76:79]
    ds_read_b128 v[28:31], v10 offset:47360
    s_waitcnt vmcnt(4)
    s_barrier
    s_waitcnt lgkmcnt(4)
    v_mfma_f32_16x16x32_bf16 v[64:67], v[180:183], v[48:51], v[64:67]
    ds_read_b128 v[32:35], v9 offset:0
    v_mfma_f32_16x16x32_bf16 v[68:71], v[180:183], v[52:55], v[68:71]
    ds_read_b128 v[36:39], v9 offset:256
    v_mfma_f32_16x16x32_bf16 v[72:75], v[180:183], v[56:59], v[72:75]
    ds_read_b128 v[40:43], v9 offset:8192
    v_mfma_f32_16x16x32_bf16 v[76:79], v[180:183], v[60:63], v[76:79]
    ds_read_b128 v[44:47], v9 offset:8448
    s_waitcnt lgkmcnt(4)
    v_mfma_f32_16x16x32_bf16 v[64:67], v[244:247], v[16:19], v[64:67]
    ds_read_b128 v[48:51], v9 offset:2048
    v_mfma_f32_16x16x32_bf16 v[68:71], v[244:247], v[20:23], v[68:71]
    ds_read_b128 v[52:55], v9 offset:2304
    v_mfma_f32_16x16x32_bf16 v[72:75], v[244:247], v[24:27], v[72:75]
    ds_read_b128 v[56:59], v9 offset:10240
    v_mfma_f32_16x16x32_bf16 v[76:79], v[244:247], v[28:31], v[76:79]
    ds_read_b128 v[60:63], v9 offset:10496
    s_waitcnt lgkmcnt(4)
    v_mfma_f32_16x16x32_bf16 v[64:67], v[136:139], v[32:35], v[64:67]
    ds_read_b128 v[16:19], v9 offset:4096
    v_mfma_f32_16x16x32_bf16 v[68:71], v[136:139], v[36:39], v[68:71]
    ds_read_b128 v[20:23], v9 offset:4352
    v_mfma_f32_16x16x32_bf16 v[72:75], v[136:139], v[40:43], v[72:75]
    ds_read_b128 v[24:27], v9 offset:12288
    v_mfma_f32_16x16x32_bf16 v[76:79], v[136:139], v[44:47], v[76:79]
    ds_read_b128 v[28:31], v9 offset:12544
    s_waitcnt lgkmcnt(4)
    v_mfma_f32_16x16x32_bf16 v[64:67], v[200:203], v[48:51], v[64:67]
    ds_read_b128 v[32:35], v9 offset:6144
    v_mfma_f32_16x16x32_bf16 v[68:71], v[200:203], v[52:55], v[68:71]
    ds_read_b128 v[36:39], v9 offset:6400
    v_mfma_f32_16x16x32_bf16 v[72:75], v[200:203], v[56:59], v[72:75]
    ds_read_b128 v[40:43], v9 offset:14336
    v_mfma_f32_16x16x32_bf16 v[76:79], v[200:203], v[60:63], v[76:79]
    ds_read_b128 v[44:47], v9 offset:14592
    s_waitcnt vmcnt(0)
    s_barrier
    s_waitcnt lgkmcnt(4)
    v_mfma_f32_16x16x32_bf16 v[64:67], v[140:143], v[16:19], v[64:67]
    ds_read_b128 v[48:51], v9 offset:32768
    v_mfma_f32_16x16x32_bf16 v[68:71], v[140:143], v[20:23], v[68:71]
    ds_read_b128 v[52:55], v9 offset:33024
    v_mfma_f32_16x16x32_bf16 v[72:75], v[140:143], v[24:27], v[72:75]
    ds_read_b128 v[56:59], v9 offset:40960
    v_mfma_f32_16x16x32_bf16 v[76:79], v[140:143], v[28:31], v[76:79]
    ds_read_b128 v[60:63], v9 offset:41216
    s_waitcnt lgkmcnt(4)
    v_mfma_f32_16x16x32_bf16 v[64:67], v[204:207], v[32:35], v[64:67]
    ds_read_b128 v[16:19], v9 offset:34816
    v_mfma_f32_16x16x32_bf16 v[68:71], v[204:207], v[36:39], v[68:71]
    ds_read_b128 v[20:23], v9 offset:35072
    v_mfma_f32_16x16x32_bf16 v[72:75], v[204:207], v[40:43], v[72:75]
    ds_read_b128 v[24:27], v9 offset:43008
    v_mfma_f32_16x16x32_bf16 v[76:79], v[204:207], v[44:47], v[76:79]
    ds_read_b128 v[28:31], v9 offset:43264
    s_waitcnt lgkmcnt(4)
    v_mfma_f32_16x16x32_bf16 v[64:67], v[152:155], v[48:51], v[64:67]
    v_mfma_f32_16x16x32_bf16 v[68:71], v[152:155], v[52:55], v[68:71]
    v_mfma_f32_16x16x32_bf16 v[72:75], v[152:155], v[56:59], v[72:75]
    v_mfma_f32_16x16x32_bf16 v[76:79], v[152:155], v[60:63], v[76:79]
    s_cmp_ge_u32 s3, 4
    s_cbranch_scc1 L_eskip
    s_waitcnt lgkmcnt(0)
    v_mfma_f32_16x16x32_bf16 v[64:67], v[216:219], v[16:19], v[64:67]
    v_mfma_f32_16x16x32_bf16 v[68:71], v[216:219], v[20:23], v[68:71]
    v_mfma_f32_16x16x32_bf16 v[72:75], v[216:219], v[24:27], v[72:75]
    v_mfma_f32_16x16x32_bf16 v[76:79], v[216:219], v[28:31], v[76:79]
L_eskip:
    s_nop 4
    ds_write_b128 v11, v[64:67] offset:0
    ds_write_b128 v11, v[68:71] offset:4352
    ds_write_b128 v11, v[72:75] offset:8704
    ds_write_b128 v11, v[76:79] offset:13056
    s_waitcnt lgkmcnt(0)
    s_barrier
    ds_read_b128 v[16:19], v5 offset:0
    ds_read_b128 v[20:23], v5 offset:17408
    ds_read_b128 v[24:27], v5 offset:8704
    ds_read_b128 v[28:31], v5 offset:26112
    s_waitcnt lgkmcnt(2)
    v_pk_add_f32 v[16:17], v[16:17], v[20:21]
    v_pk_add_f32 v[18:19], v[18:19], v[22:23]
    v_pk_fma_f32 v[16:17], v[16:17], v[120:121], v[80:81]
    v_pk_fma_f32 v[18:19], v[18:19], v[122:123], v[82:83]
    v_cvt_pk_bf16_f32 v20, v16, v17
    v_cvt_pk_bf16_f32 v21, v18, v19
    buffer_store_dwordx2 v[20:21], v4, s[48:51], s32 offen nt
    s_waitcnt lgkmcnt(0)
    v_pk_add_f32 v[24:25], v[24:25], v[28:29]
    v_pk_add_f32 v[26:27], v[26:27], v[30:31]
    v_pk_fma_f32 v[24:25], v[24:25], v[120:121], v[84:85]
    v_pk_fma_f32 v[26:27], v[26:27], v[122:123], v[86:87]
    v_cvt_pk_bf16_f32 v28, v24, v25
    v_cvt_pk_bf16_f32 v29, v26, v27
    s_add_u32 s32, s32, 32768
    buffer_store_dwordx2 v[28:29], v4, s[48:51], s32 offen nt
    s_or_b32 s76, s2, s3
    s_cmp_lg_u32 s76, 0
    s_cbranch_scc1 L_fin
    v_mov_b32 v1, s62
    s_mov_b64 exec, 1
    buffer_store_dword v1, v6, s[44:47], 0 offen sc1
    s_mov_b64 exec, -1
L_fin:
L_end:
    s_endpgm
L_again_11:
    s_mov_b32 s67, 0x40000
L_poll_12:
    buffer_load_dword v16, v3, s[44:47], s26 offen sc1
    s_sub_u32 s67, s67, 1
    s_cbranch_scc1 L_polld_13
    s_waitcnt vmcnt(0)
    v_cmp_ne_u32 vcc, s62, v16
    s_nop 0
    s_cbranch_vccnz L_poll_12
L_polld_13:
    s_waitcnt vmcnt(0)
    s_branch L_ok_10
L_again_15:
    s_mov_b32 s67, 0x40000
L_poll_16:
    buffer_load_dwordx4 v[120:123], v4, s[44:47], s79 offen sc1
    s_sub_u32 s67, s67, 1
    s_cbranch_scc1 L_polld_17
    s_waitcnt vmcnt(0)
    v_cmp_ne_u32 vcc, s62, v121
    v_xor_b32 v1, s62, v123
    v_cmp_lt_u32 s[82:83], 15, v1
    s_nop 0
    s_or_b64 vcc, vcc, s[82:83]
    s_cbranch_vccnz L_poll_16
L_polld_17:
    s_waitcnt vmcnt(0)
    s_branch L_ok_14
L_again_27:
    s_mov_b32 s67, 0x40000
L_poll_28:
    buffer_load_dword v84, v85, s[44:47], s80 offen sc1
    s_sub_u32 s67, s67, 1
    s_cbranch_scc1 L_polld_29
    s_waitcnt vmcnt(0)
    v_cmp_ne_u32 vcc, s62, v84
    s_nop 0
    s_cbranch_vccnz L_poll_28
L_polld_29:
    s_waitcnt vmcnt(0)
    s_branch L_ok_26
L_rare_31:
    s_lshl_b32 s76, s2, 7
    s_add_u32 s76, s76, 65540
    s_mov_b64 exec, 1
    buffer_store_dword v91, v6, s[44:47], s76 offen sc1
    s_mov_b64 exec, -1
    s_branch L_back_32
L_rare_33:
    s_lshl3_add_u32 s76, s64, s3
    s_lshl_b32 s74, s60, 6
    s_add_u32 s74, s74, s76
    s_lshl_b32 s74, s74, 9
    s_add_u32 s74, s74, 0x20000
    s_lshr_b32 s77, s76, 4
    s_lshl3_add_u32 s77, s77, s60
    s_lshl_b32 s77, s77, 7
    s_and_b32 s76, s76, 15
    s_mul_i32 s78, s76, 196608
    s_add_u32 s77, s77, s78
    s_add_u32 s77, s77, 2048
    s_lshl_b32 s76, s76, 6
    v_and_b32 v104, 31, v0
    v_lshl_add_u32 v104, v104, 1, s76
    global_load_ushort v136, v104, s[16:17]
    v_lshrrev_b32 v104, 3, v0
    v_mul_u32_u24 v104, 6144, v104
    v_and_b32 v105, 0x70, v6
    v_add3_u32 v106, v104, v105, s77
    s_lshl_b32 s77, s3, 12
    s_add_u32 m0, s77, 99072
    s_nop 0
    global_load_lds_dwordx4 v106, s[18:19]
    s_add_u32 m0, s77, 100096
    v_add_u32 v106, 49152, v106
    global_load_lds_dwordx4 v106, s[18:19]
    s_add_u32 m0, s77, 101120
    v_add_u32 v106, 49152, v106
    global_load_lds_dwordx4 v106, s[18:19]
    s_add_u32 m0, s77, 102144
    v_add_u32 v106, 49152, v106
    global_load_lds_dwordx4 v106, s[18:19]
    v_lshrrev_b32 v101, 5, v0
    v_bfe_u32 v102, v0, 2, 2
    v_lshl_add_u32 v102, v101, 3, v102
    s_lshl_b32 s76, s3, 12
    s_add_u32 s76, s76, 99072
    v_lshl_add_u32 v102, v102, 7, s76
    v_and_b32 v100, 1, v7
    v_lshl_add_u32 v102, v100, 5, v102
    v_and_b32 v100, 3, v0
    v_lshl_add_u32 v102, v100, 3, v102
    s_lshl_b32 s76, s3, 7
    s_add_u32 s76, s76, 148480
    v_lshl_add_u32 v100, v0, 1, s76
    v_lshl_add_u32 v101, v101, 4, s76
    s_branch L_back_34
L_rare_35:
    s_waitcnt vmcnt(6)
    v_lshlrev_b32 v136, 16, v136
    v_mul_f32 v137, 0xbfb8aa3b, v136
    v_exp_f32 v137, v137
    s_nop 0
    v_add_f32 v137, 1.0, v137
    v_rcp_f32 v137, v137
    s_nop 0
    v_mul_f32 v136, v136, v137
    v_cvt_pk_bf16_f32 v136, v136, v136
    ds_write_b16 v100, v136
    ds_read_b128 v[140:143], v101
    ds_read_b128 v[144:147], v101 offset:32
    s_branch L_back_36
L_rare_37:
    ds_read_b64_tr_b16 v[148:149], v102 offset:0
    ds_read_b64_tr_b16 v[150:151], v102 offset:512
    ds_read_b64_tr_b16 v[152:153], v102 offset:64
    ds_read_b64_tr_b16 v[154:155], v102 offset:576
    ds_read_b64_tr_b16 v[156:157], v102 offset:2048
    ds_read_b64_tr_b16 v[158:159], v102 offset:2560
    ds_read_b64_tr_b16 v[160:161], v102 offset:2112
    ds_read_b64_tr_b16 v[162:163], v102 offset:2624
    s_branch L_back_38
L_rare_39:
    v_mfma_f32_32x32x16_bf16 v[164:179], v[140:143], v[148:151], 0
    v_mfma_f32_32x32x16_bf16 v[180:195], v[140:143], v[152:155], 0
    v_mfma_f32_32x32x16_bf16 v[164:179], v[144:147], v[156:159], v[164:179]
    s_waitcnt lgkmcnt(3)
    v_mfma_f32_32x32x16_bf16 v[180:195], v[144:147], v[160:163], v[180:195]
    s_branch L_back_40
L_rare_41:
    s_add_u32 s77, s74, 3932160
    s_add_u32 s76, s74, 3538944
    v_mov_b32 v137, s62
    s_mov_b32 vcc_lo, 0
    s_mov_b32 vcc_hi, -1
    v_cndmask_b32 v136, v164, v180, vcc
    buffer_store_dwordx2 v[136:137], v103, s[44:47], s76 offen sc1
    s_branch L_back_42
L_again_44:
    s_mov_b32 s67, 0x40000
L_poll_45:
    s_sleep 8
    buffer_load_dword v84, v85, s[44:47], s81 offen sc1
    s_sub_u32 s67, s67, 1
    s_cbranch_scc1 L_polld_46
    s_waitcnt vmcnt(0)
    v_cmp_ne_u32 vcc, s62, v84
    s_nop 0
    s_cbranch_vccnz L_poll_45
L_polld_46:
    s_waitcnt vmcnt(0)
    s_branch L_ok_43
L_rare_47:
    s_lshl2_add_u32 s76, s60, s64
    s_lshl_b32 s76, s76, 13
    s_add_u32 s76, s76, 3637248
    s_add_u32 s77, s76, 4096
    s_mov_b32 s67, 0x40000
L_poll_49:
    buffer_load_dwordx4 v[220:223], v6, s[44:47], s76 offen offset:0 sc1
    buffer_load_dwordx4 v[224:227], v6, s[44:47], s76 offen offset:1024 sc1
    buffer_load_dwordx4 v[228:231], v6, s[44:47], s76 offen offset:2048 sc1
    buffer_load_dwordx4 v[232:235], v6, s[44:47], s76 offen offset:3072 sc1
    buffer_load_dwordx4 v[236:239], v6, s[44:47], s77 offen offset:0 sc1
    buffer_load_dwordx4 v[240:243], v6, s[44:47], s77 offen offset:1024 sc1
    buffer_load_dwordx4 v[244:247], v6, s[44:47], s77 offen offset:2048 sc1
    buffer_load_dwordx4 v[248:251], v6, s[44:47], s77 offen offset:3072 sc1
    s_sub_u32 s67, s67, 1
    s_cbranch_scc1 L_polld_50
    s_waitcnt vmcnt(0)
    v_cmp_ne_u32 vcc, s62, v221
    v_cmp_ne_u32 s[82:83], s62, v223
    s_nop 0
    s_or_b64 vcc, vcc, s[82:83]
    v_cmp_ne_u32 s[82:83], s62, v225
    s_nop 0
    s_or_b64 vcc, vcc, s[82:83]
    v_cmp_ne_u32 s[82:83], s62, v227
    s_nop 0
    s_or_b64 vcc, vcc, s[82:83]
    v_cmp_ne_u32 s[82:83], s62, v229
    s_nop 0
    s_or_b64 vcc, vcc, s[82:83]
    v_cmp_ne_u32 s[82:83], s62, v231
    s_nop 0
    s_or_b64 vcc, vcc, s[82:83]
    v_cmp_ne_u32 s[82:83], s62, v233
    s_nop 0
    s_or_b64 vcc, vcc, s[82:83]
    v_cmp_ne_u32 s[82:83], s62, v235
    s_nop 0
    s_or_b64 vcc, vcc, s[82:83]
    v_cmp_ne_u32 s[82:83], s62, v237
    s_nop 0
    s_or_b64 vcc, vcc, s[82:83]
    v_cmp_ne_u32 s[82:83], s62, v239
    s_nop 0
    s_or_b64 vcc, vcc, s[82:83]
    v_cmp_ne_u32 s[82:83], s62, v241
    s_nop 0
    s_or_b64 vcc, vcc, s[82:83]
    v_cmp_ne_u32 s[82:83], s62, v243
    s_nop 0
    s_or_b64 vcc, vcc, s[82:83]
    v_cmp_ne_u32 s[82:83], s62, v245
    s_nop 0
    s_or_b64 vcc, vcc, s[82:83]
    v_cmp_ne_u32 s[82:83], s62, v247
    s_nop 0
    s_or_b64 vcc, vcc, s[82:83]
    v_cmp_ne_u32 s[82:83], s62, v249
    s_nop 0
    s_or_b64 vcc, vcc, s[82:83]
    v_cmp_ne_u32 s[82:83], s62, v251
    s_nop 0
    s_or_b64 vcc, vcc, s[82:83]
    s_cbranch_vccnz L_poll_49
L_polld_50:
    s_waitcnt vmcnt(0)
    v_add_f32 v220, v220, v224
    v_add_f32 v222, v222, v226
    v_add_f32 v220, v220, v228
    v_add_f32 v222, v222, v230
    v_add_f32 v220, v220, v232
    v_add_f32 v222, v222, v234
    v_add_f32 v220, v220, v236
    v_add_f32 v222, v222, v238
    v_add_f32 v220, v220, v240
    v_add_f32 v222, v222, v242
    v_add_f32 v220, v220, v244
    v_add_f32 v222, v222, v246
    v_add_f32 v220, v220, v248
    v_add_f32 v222, v222, v250
    v_mov_b32 v221, v220
    v_mov_b32 v223, v222
    s_cmp_eq_u32 s64, 6
    s_cselect_b32 s77, 1.0, 0
    v_permlane32_swap_b32 v220, v221
    v_permlane32_swap_b32 v222, v223
    v_add_f32 v220, v220, v221
    v_add_f32 v222, v222, v223
    v_cvt_pk_bf16_f32 v220, v220, v222
    v_lshlrev_b32 v222, 16, v220
    v_and_b32 v223, 0xffff0000, v220
    v_add_f32 v222, s77, v222
    v_add_f32 v223, s77, v223
    v_cvt_pk_bf16_f32 v220, v222, v223
    v_mov_b32 v221, s62
    s_lshl3_add_u32 s76, s64, s60
    s_lshl_b32 s76, s76, 8
    s_add_u32 s76, s76, 0
    s_mov_b32 exec_hi, 0
    buffer_store_dwordx2 v[220:221], v103, s[44:47], s76 offen sc1
    s_mov_b32 exec_hi, -1
    s_branch L_back_48
L_rare_52:
    v_and_b32 v86, 0x800, v13
    v_lshl_add_u32 v86, v86, 1, v13
    s_lshl_b32 s81, s64, 8
    s_add_u32 s81, s81, 8192
    buffer_load_dwordx2 v[88:89], v86, s[44:47], s81 offen sc1
    s_branch L_back_53
L_again_55:
    s_mov_b32 s67, 0x40000
L_poll_56:
    buffer_load_dwordx2 v[108:109], v13, s[44:47], s27 offen sc1
    s_sub_u32 s67, s67, 1
    s_cbranch_scc1 L_polld_57
    s_waitcnt vmcnt(0)
    v_cmp_ne_u32 vcc, s62, v109
    s_nop 0
    s_cbranch_vccnz L_poll_56
L_polld_57:
    s_waitcnt vmcnt(0)
    s_branch L_ok_54
L_again_61:
    s_mov_b32 s67, 0x40000
L_poll_62:
    buffer_load_dwordx2 v[88:89], v86, s[44:47], s81 offen sc1
    s_sub_u32 s67, s67, 1
    s_cbranch_scc1 L_polld_63
    s_waitcnt vmcnt(0)
    v_cmp_ne_u32 vcc, s62, v89
    s_nop 0
    s_cbranch_vccnz L_poll_62
L_polld_63:
    s_waitcnt vmcnt(0)
    s_branch L_ok_60
L_rare_58:
    v_cmp_ne_u32 vcc, s62, v89
    s_nop 0
    s_cbranch_vccnz L_again_61
L_ok_60:
    v_lshlrev_b32 v86, 2, v0
    v_add_u32 v86, 150016, v86
    ds_write_b32 v86, v88
    s_branch L_back_59
L_safe_65:
    buffer_store_dwordx4 v[20:23], v6, s[44:47], s4 offen sc1
    s_waitcnt vmcnt(1)
    v_lshlrev_b32 v1, 2, v8
    v_and_b32 v11, 1, v0
    v_mul_u32_u24 v11, 1088, v11
    v_lshl_add_u32 v11, v7, 4, v11
    v_add_u32 v11, 150528, v11
    v_lshlrev_b32 v9, 9, v7
    v_lshl_add_u32 v9, v8, 4, v9
    v_add_u32 v9, 65536, v9
    v_add_u32 v10, s36, v6
    s_waitcnt vmcnt(0)
    s_mov_b64 exec, 1
    buffer_store_dword v18, v6, s[44:47], s5 offen sc1
    s_mov_b64 exec, -1
    s_branch L_pubd_66
L_safe_67:
    buffer_store_dwordx4 v[16:19], v6, s[44:47], s9 offen sc1
    v_permlane16_swap_b32 v20, v22
    v_permlane16_swap_b32 v21, v23
    buffer_store_dwordx4 v[20:23], v6, s[44:47], s10 offen sc1
    v_cvt_pk_bf16_f32 v24, v64, v65
    v_cvt_pk_bf16_f32 v25, v66, v67
    v_cvt_pk_bf16_f32 v26, v68, v69
    v_cvt_pk_bf16_f32 v27, v70, v71
    v_cvt_pk_bf16_f32 v28, v72, v73
    v_cvt_pk_bf16_f32 v29, v74, v75
    v_cvt_pk_bf16_f32 v30, v76, v77
    v_cvt_pk_bf16_f32 v31, v78, v79
    v_dot2_f32_bf16 v40, v24, v2, 0
    v_dot2_f32_bf16 v41, v24, v24, 0
    v_dot2_f32_bf16 v42, v26, v2, 0
    v_dot2_f32_bf16 v43, v26, v26, 0
    v_dot2_f32_bf16 v44, v28, v2, 0
    v_dot2_f32_bf16 v45, v28, v28, 0
    v_dot2_f32_bf16 v46, v30, v2, 0
    v_dot2_f32_bf16 v47, v30, v30, 0
    v_dot2_f32_bf16 v40, v25, v2, v40
    v_dot2_f32_bf16 v41, v25, v25, v41
    v_dot2_f32_bf16 v42, v27, v2, v42
    v_dot2_f32_bf16 v43, v27, v27, v43
    v_dot2_f32_bf16 v44, v29, v2, v44
    v_dot2_f32_bf16 v45, v29, v29, v45
    v_dot2_f32_bf16 v46, v31, v2, v46
    v_dot2_f32_bf16 v47, v31, v31, v47
    ds_write_b64 v4, v[24:25] offset:0
    ds_write_b64 v4, v[26:27] offset:2304
    ds_write_b64 v4, v[28:29] offset:4608
    ds_write_b64 v4, v[30:31] offset:6912
    v_permlane32_swap_b32 v40, v44
    v_permlane32_swap_b32 v41, v45
    v_permlane32_swap_b32 v42, v46
    v_permlane32_swap_b32 v43, v47
    v_pk_add_f32 v[40:41], v[40:41], v[44:45]
    v_pk_add_f32 v[42:43], v[42:43], v[46:47]
    s_nop 1
    v_permlane16_swap_b32 v40, v42
    v_permlane16_swap_b32 v41, v43
    v_pk_add_f32 v[40:41], v[40:41], v[42:43]
    buffer_store_dwordx2 v[40:41], v3, s[44:47], s11 offen sc1
    s_waitcnt vmcnt(1)
    s_mov_b64 exec, 1
    buffer_store_dword v1, v6, s[44:47], s12 offen sc1
    s_mov_b64 exec, -1
    s_barrier
    s_waitcnt vmcnt(1)
    s_add_u32 s12, s12, 128
    s_mov_b64 exec, 1
    buffer_store_dword v1, v6, s[44:47], s12 offen sc1
    s_mov_b64 exec, -1
    s_branch L_pubd_68
L_safe_75:
    buffer_store_dwordx4 v[16:19], v6, s[44:47], s15 offen sc1
    buffer_store_dwordx4 v[20:23], v6, s[44:47], s16 offen sc1
    s_branch L_pubd_76
L_safe_77:
    buffer_store_dwordx4 v[24:27], v6, s[44:47], s15 offen offset:1024 sc1
    buffer_store_dwordx4 v[28:31], v6, s[44:47], s16 offen offset:1024 sc1
    s_waitcnt vmcnt(0)
    s_mov_b64 exec, 1
    buffer_store_dword v2, v6, s[44:47], s17 offen sc1
    s_mov_b64 exec, -1
    s_branch L_pubd_78
L_safe_79:
    buffer_store_dwordx4 v[24:27], v6, s[44:47], s15 offen sc1
    buffer_store_dwordx4 v[28:31], v6, s[44:47], s16 offen sc1
    s_waitcnt vmcnt(0)
    s_mov_b64 exec, 1
    buffer_store_dword v2, v6, s[44:47], s17 offen sc1
    s_mov_b64 exec, -1
    s_branch L_pubd_80
L_safe_81:
    s_mov_b64 exec, 1
    buffer_store_dword v2, v6, s[44:47], s17 offen sc1
    s_mov_b64 exec, -1
    s_branch L_pubd_82
L_slow:
    s_waitcnt vmcnt(0) lgkmcnt(0)
    v_mov_b32 v32, 0xff800000
    s_mov_b32 s77, s68
    s_mov_b32 s76, 64
L_slow1:
    buffer_load_dwordx4 v[68:71], v6, s[44:47], s77 offen sc1
    s_add_u32 s77, s77, 2048
    s_waitcnt vmcnt(0)
    v_mfma_f32_32x32x16_bf16 v[16:31], v[68:71], v[64:67], 0
    s_nop 11
    v_max3_f32 v32, v32, v16, v17
    v_max3_f32 v32, v32, v18, v19
    v_max3_f32 v32, v32, v20, v21
    v_max3_f32 v32, v32, v22, v23
    v_max3_f32 v32, v32, v24, v25
    v_max3_f32 v32, v32, v26, v27
    v_max3_f32 v32, v32, v28, v29
    v_max3_f32 v32, v32, v30, v31
    s_sub_u32 s76, s76, 1
    s_cmp_lg_u32 s76, 0
    s_cbranch_scc1 L_slow1
    v_mov_b32 v33, v32
    s_nop 1
    v_permlane32_swap_b32 v32, v33
    v_max_f32 v32, v32, v33
    v_sub_f32 v32, 0, v32
    v_mov_b32 v33, v32
    v_mov_b32 v34, v32
    v_mov_b32 v35, v32
    v_mov_b32 v36, v32
    v_mov_b32 v37, v32
    v_mov_b32 v38, v32
    v_mov_b32 v39, v32
    v_mov_b32 v40, v32
    v_mov_b32 v41, v32
    v_mov_b32 v42, v32
    v_mov_b32 v43, v32
    v_mov_b32 v44, v32
    v_mov_b32 v45, v32
    v_mov_b32 v46, v32
    v_mov_b32 v47, v32
    v_mov_b32 v48, 0
    v_mov_b32 v49, 0
    v_mov_b32 v50, 0
    v_mov_b32 v51, 0
    v_mov_b32 v52, 0
    v_mov_b32 v53, 0
    v_mov_b32 v54, 0
    v_mov_b32 v55, 0
    v_mov_b32 v56, 0
    v_mov_b32 v57, 0
    v_mov_b32 v58, 0
    v_mov_b32 v59, 0
    v_mov_b32 v60, 0
    v_mov_b32 v61, 0
    v_mov_b32 v62, 0
    v_mov_b32 v63, 0
    v_lshrrev_b32 v4, 5, v0
    v_lshlrev_b32 v4, 8, v4
    v_lshl_add_u32 v4, v8, 4, v4
    v_mov_b32 v1, 0x3f803f80
    s_mov_b32 vcc_lo, 0x00010000
    s_mov_b32 vcc_hi, 0x00010000
    v_cndmask_b32 v72, 0, v1, vcc
    v_mov_b32 v73, v72
    v_mov_b32 v74, v72
    v_mov_b32 v75, v72
    v_mov_b32 v76, v72
    v_mov_b32 v77, v72
    v_mov_b32 v78, v72
    v_mov_b32 v79, v72
    s_mov_b32 s77, s68
    s_mov_b32 s76, 64
L_slow2:
    buffer_load_dwordx4 v[68:71], v6, s[44:47], s77 offen sc1
    s_mov_b32 exec_lo, 0xffff
    s_mov_b32 exec_hi, 0xffff
    buffer_load_dwordx4 v[76:79], v4, s[44:47], s77 offen offset:1024 sc1
    buffer_load_dwordx4 v[72:75], v4, s[44:47], s77 offen offset:1536 sc1
    s_mov_b64 exec, -1
    s_add_u32 s77, s77, 2048
    s_waitcnt vmcnt(0)
    v_mfma_f32_32x32x16_bf16 v[16:31], v[68:71], v[64:67], v[32:47]
    s_nop 11
    v_exp_f32 v16, v16
    v_exp_f32 v17, v17
    v_exp_f32 v18, v18
    v_exp_f32 v19, v19
    v_exp_f32 v20, v20
    v_exp_f32 v21, v21
    v_exp_f32 v22, v22
    v_exp_f32 v23, v23
    v_exp_f32 v24, v24
    v_exp_f32 v25, v25
    v_exp_f32 v26, v26
    v_exp_f32 v27, v27
    v_exp_f32 v28, v28
    v_exp_f32 v29, v29
    v_exp_f32 v30, v30
    v_exp_f32 v31, v31
    v_smfmac_f32_32x32x32_bf16 v[48:63], v[76:79], v[16:23], v2
    s_nop 0
    v_smfmac_f32_32x32x32_bf16 v[48:63], v[72:75], v[24:31], v2
    s_sub_u32 s76, s76, 1
    s_cmp_lg_u32 s76, 0
    s_cbranch_scc1 L_slow2
    s_nop 8
    v_mov_b32 v16, v56
    s_nop 1
    v_permlane32_swap_b32 v16, v56
    s_branch L_attn_done
    s_endpgm
L_code_end:
.p2align 8
.fill 64, 4, 0xbf810000
.section .rodata,"a"
.p2align 6
.amdhsa_kernel adaLN_cond__softmax_full_mha__dense_activation_relu__prompt_kernel
  .amdhsa_next_free_vgpr 256
  .amdhsa_next_free_sgpr 102
  .amdhsa_accum_offset 256
  .amdhsa_group_segment_fixed_size 0
  .amdhsa_kernarg_size 88
  .amdhsa_user_sgpr_count 2
  .amdhsa_user_sgpr_kernarg_segment_ptr 1
  .amdhsa_system_sgpr_workgroup_id_x 1
.end_amdhsa_kernel
```
